```python
import torch

def _softmax(x, axis=-1):
    return torch.softmax(x, dim=axis)
def _gelu(x):
    return torch.nn.functional.gelu(x, approximate="tanh")
def _silu(x):
    return torch.nn.functional.silu(x)
def _sigmoid(x):
    return torch.sigmoid(x)
def _layernorm(x, axis=-1, eps=1e-5):
    m = x.mean(dim=axis, keepdim=True)
    v = x.var(dim=axis, keepdim=True, unbiased=False)
    return (x - m) / torch.sqrt(v + eps)
def _scatter_add(tgt, idx, src, axis=0):
    return tgt.clone().index_add_(axis, idx, src)
def _segment_sum(src, seg, n):
    out = torch.zeros((n,) + src.shape[1:], dtype=src.dtype)
    return out.index_add_(0, seg, src)
def _pad(x, pw):
    flat = tuple(v for pair in reversed(pw) for v in pair)
    return torch.nn.functional.pad(x, flat)

kernel_name = 'recurrent_scan__spectral_gfnet__mixer_channel_mlp__prompt'

def setup_inputs():

    _w = (lambda a: (lambda t: t.to(torch.bfloat16) if t.is_floating_point() else t)(torch.as_tensor(a)))
    def _A_setup():
        B, S, D = 1, 2048, 640
        Df = D // 2 + 1
        return {
            "x": _w((lambda *s: torch.randn(*s, dtype=torch.bfloat16) * 0.05)(B, S, D)),
            "w_r": _w((lambda *s: torch.randn(*s, dtype=torch.bfloat16) * 0.8)(S, Df) * 0.02),
            "w_i": _w((lambda *s: torch.randn(*s, dtype=torch.bfloat16) * 0.8)(S, Df) * 0.02),
        }
    _A_in = _A_setup()

    def _B_setup():
        B, S, D, F = 1, 2048, 640, 1728
        return {
            "x": _w((lambda *s: torch.randn(*s, dtype=torch.bfloat16) * 0.05)(B, S, D)),
            "w1": _w((lambda *s: torch.randn(*s, dtype=torch.bfloat16) * 0.8)(D, F) * (D ** -0.5)),
            "b1": _w((lambda *s: torch.randn(*s, dtype=torch.bfloat16) * 0.8)(F)),
            "w2": _w((lambda *s: torch.randn(*s, dtype=torch.bfloat16) * 0.8)(F, D) * (F ** -0.5)),
            "b2": _w((lambda *s: torch.randn(*s, dtype=torch.bfloat16) * 0.2)(D)),
        }
    _B_in = _B_setup()

    return {
        "A_x": _A_in["x"],
        "A_w_r": _A_in["w_r"],
        "A_w_i": _A_in["w_i"],
        "B_x": _B_in["x"],
        "B_w1": _B_in["w1"],
        "B_b1": _B_in["b1"],
        "B_w2": _B_in["w2"],
        "B_b2": _B_in["b2"],
    }

def reference(A_x, A_w_r, A_w_i, B_x, B_w1, B_b1, B_w2, B_b2):
    def _A_ref(x, w_r, w_i):
        B, S, D = x.shape
        X = (lambda x, axes=(-2,-1): torch.fft.rfft2(x.float(), dim=axes))(x, axes=(-2, -1))
        W = w_r + 1j * w_i
        X = X * W
        y = (lambda x, s, axes=(-2,-1): torch.fft.irfft2(x, s=s, dim=axes).to(torch.bfloat16))(X, (S, D), axes=(-2, -1))
        return y

    def _B_ref(x, w1, b1, w2, b2):
        y = _layernorm(x, axis=-1)
        h = _gelu(torch.einsum("bsd,df->bsf", y, w1) + b1)
        return torch.einsum("bsf,fd->bsd", h, w2) + b2

    x = A_x
    xn = _layernorm(x, axis=-1)
    s = _A_ref(xn, A_w_r, A_w_i)
    g = _silu(_B_ref(xn, B_w1, B_b1, B_w2, B_b2))
    return x + s * g
```

```asm
; @launch grid=(256,1,1) block=(768,1,1) lds=157664
.amdgcn_target "amdgcn-amd-amdhsa--gfx950"
.text
.globl recurrent_scan__spectral_gfnet__mixer_channel_mlp__prompt_kernel
.p2align 8
.type recurrent_scan__spectral_gfnet__mixer_channel_mlp__prompt_kernel,@function
recurrent_scan__spectral_gfnet__mixer_channel_mlp__prompt_kernel:
    s_cmp_ge_u32 s2, 256
    s_cbranch_scc1 Ldone
    s_load_dwordx16 s[4:19], s[0:1], 0
    s_load_dwordx4 s[20:23], s[0:1], 64
    s_load_dwordx2 s[24:25], s[0:1], 80
    s_getpc_b64 s[28:29]
Lpc:
    s_sub_u32 s52, s28, Lpc-recurrent_scan__spectral_gfnet__mixer_channel_mlp__prompt_kernel
    s_subb_u32 s53, s29, 0
    s_mov_b32 s54, ctab-recurrent_scan__spectral_gfnet__mixer_channel_mlp__prompt_kernel+12288
    s_mov_b32 s55, 0x00020000
    s_add_u32 s28, s28, ctab-Lpc
    s_addc_u32 s29, s29, 0
    v_lshrrev_b32 v1, 6, v0
    s_nop 0
    v_readfirstlane_b32 s26, v1
    v_and_b32 v0, 63, v0
    s_and_b32 s60, s2, 7
    s_lshr_b32 s61, s2, 3
    s_cmp_lt_u32 s26, 4
    s_cbranch_scc1 Lfft
    s_and_b32 s62, s60, 6
    s_lshl_b32 s62, s62, 1
    s_and_b32 s58, s61, 3
    s_add_u32 s62, s62, s58
    s_and_b32 s63, s60, 1
    s_mul_i32 s63, s63, 7
    s_lshr_b32 s58, s61, 2
    s_add_u32 s63, s63, s58
    s_cmp_ge_u32 s26, 8
    s_cbranch_scc1 Lload
    s_sub_u32 s26, s26, 4
    v_lshlrev_b32 v13, 7, v0
    s_lshl_b32 s58, s61, 2
    s_add_u32 s58, s58, s26
    s_lshl_b32 s58, s58, 9
    s_mov_b64 exec, 0xf
    buffer_load_dword v15, v13, s[52:55], s58 offen
    s_mov_b64 exec, -1
    v_lshrrev_b32 v32, 5, v0
    v_and_b32 v33, 31, v0
    v_cvt_f32_u32 v34, v32
    v_mul_f32 v34, 4.0, v34
    v_cvt_f32_u32 v35, v33
    v_mul_f32 v35, 0x3d000000, v35
    s_lshl_b32 s58, s26, 3
    v_cvt_f32_u32 v36, s58
    v_add_f32 v36, v36, v34
    v_mul_f32 v36, v36, v35
    v_cmp_gt_u32 vcc, 16, v33
    v_mov_b32 v37, 0x80000000
    v_mov_b32 v38, 0x8000
    v_cndmask_b32 v37, v37, v38, vcc
    v_fmamk_f32 v40, v35, 0x00000000, v36
    v_fmamk_f32 v41, v35, 0x3f800000, v36
    v_fmamk_f32 v42, v35, 0x40000000, v36
    v_fmamk_f32 v43, v35, 0x40400000, v36
    v_cos_f32 v44, v40
    v_sin_f32 v40, v40
    v_cos_f32 v45, v41
    v_sin_f32 v41, v41
    v_cos_f32 v46, v42
    v_sin_f32 v42, v42
    v_cos_f32 v47, v43
    v_sin_f32 v43, v43
    v_cvt_pk_bf16_f32 v48, v44, v40
    v_cvt_pk_bf16_f32 v49, v45, v41
    v_cvt_pk_bf16_f32 v50, v46, v42
    v_cvt_pk_bf16_f32 v51, v47, v43
    v_alignbit_b32 v52, v48, v48, 16
    v_xor_b32 v52, v37, v52
    v_alignbit_b32 v53, v49, v49, 16
    v_xor_b32 v53, v37, v53
    v_alignbit_b32 v54, v50, v50, 16
    v_xor_b32 v54, v37, v54
    v_alignbit_b32 v55, v51, v51, 16
    v_xor_b32 v55, v37, v55
    s_lshl_b32 s58, s26, 10
    s_add_u32 s58, s58, 114688
    v_lshlrev_b32 v39, 4, v0
    v_add_u32 v38, s58, v39
    ds_write_b128 v38, v[48:51] offset:6144
    ds_write_b128 v38, v[52:55] offset:10240
    s_cmp_ge_u32 s26, 2
    s_cbranch_scc1 Lkg
    v_and_b32 v35, 15, v0
    v_cvt_f32_u32 v35, v35
    v_mul_f32 v35, 0x3d4ccccd, v35
    v_mul_f32 v36, 0x40200000, v34
    v_mul_f32 v36, v36, v35
    v_cvt_f32_u32 v37, s26
    v_fmac_f32 v36, 0x3e800000, v37
    v_fmamk_f32 v40, v35, 0x00000000, v36
    v_fmamk_f32 v41, v35, 0x3f800000, v36
    v_fmamk_f32 v42, v35, 0x40000000, v36
    v_fmamk_f32 v43, v35, 0x40400000, v36
    v_fmamk_f32 v44, v35, 0x40800000, v36
    v_fmamk_f32 v45, v35, 0x40a00000, v36
    v_fmamk_f32 v46, v35, 0x40c00000, v36
    v_fmamk_f32 v47, v35, 0x40e00000, v36
    v_fmamk_f32 v48, v35, 0x41000000, v36
    v_fmamk_f32 v49, v35, 0x41100000, v36
    v_cos_f32 v40, v40
    v_cos_f32 v41, v41
    v_cos_f32 v42, v42
    v_cos_f32 v43, v43
    v_cos_f32 v44, v44
    v_cos_f32 v45, v45
    v_cos_f32 v46, v46
    v_cos_f32 v47, v47
    v_cos_f32 v48, v48
    v_cos_f32 v49, v49
    v_cmp_gt_u32 s[58:59], 11, v33
    v_subrev_u32 v33, 16, v33
    v_cmp_gt_u32 vcc, 11, v33
    v_cvt_pk_bf16_f32 v40, v40, v41
    v_cvt_pk_bf16_f32 v41, v42, v43
    v_cvt_pk_bf16_f32 v42, v44, v45
    v_cvt_pk_bf16_f32 v43, v46, v47
    v_cvt_pk_bf16_f32 v44, v48, v49
    v_cndmask_b32 v52, 0, v40, s[58:59]
    v_cndmask_b32 v57, 0, v40, vcc
    v_cndmask_b32 v53, 0, v41, s[58:59]
    v_cndmask_b32 v58, 0, v41, vcc
    v_cndmask_b32 v54, 0, v42, s[58:59]
    v_cndmask_b32 v59, 0, v42, vcc
    v_cndmask_b32 v55, 0, v43, s[58:59]
    v_cndmask_b32 v60, 0, v43, vcc
    v_cndmask_b32 v56, 0, v44, s[58:59]
    v_cndmask_b32 v61, 0, v44, vcc
    v_mov_b32 v62, 0
    v_mov_b32 v63, 0
    s_mul_i32 s58, s26, 3072
    s_add_u32 s58, s58, 114688
    v_add_u32 v38, s58, v39
    ds_write_b128 v38, v[52:55] offset:0
    ds_write_b128 v38, v[56:59] offset:1024
    ds_write_b128 v38, v[60:63] offset:2048
Lkg:
    s_cmp_ge_u32 s61, 28
    s_cbranch_scc1 Lwj_c
    s_mul_i32 s58, s61, 19
    v_add_u32 v20, s58, v0
    s_lshr_b32 s59, s60, 1
    s_lshl_b32 s59, s59, 8
    v_lshrrev_b32 v21, 8, v20
    v_mul_u32_u24 v21, 768, v21
    v_add3_u32 v21, v21, v20, s59
    v_mul_u32_u24 v16, 1280, v21
    v_mov_b32 v22, 2146435072
    v_cmp_gt_u32 vcc, 19, v0
    s_nop 1
    v_cndmask_b32 v16, v22, v16, vcc
    v_cmp_gt_u32 vcc, 0x200, v20
    s_nop 1
    v_cndmask_b32 v16, v22, v16, vcc
    s_lshl_b32 s58, s61, 5
    v_add_u32 v20, s58, v0
    v_mul_u32_u24 v21, 4682, v20
    v_lshrrev_b32 v21, 16, v21
    v_mul_u32_u24 v23, 14, v21
    v_sub_u32 v20, v20, v23
    v_mul_u32_u24 v21, 3456, v21
    v_lshl_add_u32 v17, v20, 7, v21
    s_and_b32 s58, s60, 1
    s_mul_i32 s58, s58, 1792
    v_add_u32 v17, s58, v17
    v_cmp_gt_u32 vcc, 32, v0
    s_nop 1
    v_cndmask_b32 v17, v22, v17, vcc
    s_lshl_b32 s64, s26, 7
    s_mul_i32 s65, s26, 221184
    s_waitcnt lgkmcnt(0)
    s_mov_b32 s36, s4
    s_mov_b32 s37, s5
    s_mov_b32 s38, 2621440
    s_mov_b32 s39, 0x00020000
    s_mov_b32 s40, s12
    s_mov_b32 s41, s13
    s_mov_b32 s42, 2211840
    s_mov_b32 s43, 0x00020000
    s_or_b32 s58, s2, s26
    s_cmp_lg_u32 s58, 0
    s_cbranch_scc1 Lnopub
    s_mov_b32 s44, s22
    s_mov_b32 s45, s23
    s_mov_b32 s46, 256
    s_mov_b32 s47, 0x00020000
    s_memrealtime s[58:59]
    s_waitcnt lgkmcnt(0)
    s_or_b32 s58, s58, 1
    v_mov_b32 v20, s58
    v_mov_b32 v21, 0
    v_mov_b32 v22, 0
    s_mov_b64 exec, 1
    buffer_atomic_cmpswap v[20:21], v22, s[44:47], 0 offen sc1
    s_mov_b64 exec, -1
Lnopub:
    s_barrier
    buffer_load_dword v14, v16, s[36:39], s64 offen
    buffer_load_dword v14, v17, s[40:43], s65 offen
    s_add_u32 s64, s64, 512
    s_add_u32 s65, s65, 884736
    buffer_load_dword v14, v16, s[36:39], s64 offen
    buffer_load_dword v14, v17, s[40:43], s65 offen
    s_add_u32 s64, s64, 512
    s_add_u32 s65, s65, 884736
    s_cmp_gt_u32 s26, 1
    s_cbranch_scc1 Lt3
    buffer_load_dword v14, v16, s[36:39], s64 offen
    buffer_load_dword v14, v17, s[40:43], s65 offen
    s_add_u32 s64, s64, 512
    s_add_u32 s65, s65, 884736
Lt3:
    s_lshr_b32 s56, s26, 1
    s_and_b32 s57, s26, 1
    v_lshrrev_b32 v20, 5, v0
    v_and_b32 v21, 31, v0
    v_bfe_u32 v22, v0, 1, 3
    v_xor_b32 v22, v22, v20
    v_lshlrev_b32 v22, 4, v22
    v_lshl_add_u32 v22, v21, 7, v22
    s_lshl_b32 s58, s56, 13
    v_add_u32 v2, s58, v22
    v_xor_b32 v3, 32, v2
    v_xor_b32 v4, 64, v2
    v_xor_b32 v5, 96, v2
    v_add_u32 v6, 0x10000, v2
    v_add_u32 v7, 0x10000, v3
    v_add_u32 v8, 0x10000, v4
    v_add_u32 v9, 0x10000, v5
    v_bfe_u32 v22, v0, 2, 2
    v_lshl_add_u32 v23, v20, 3, v22
    v_lshlrev_b32 v23, 8, v23
    v_bfe_u32 v24, v0, 4, 1
    v_lshl_add_u32 v23, v24, 5, v23
    v_and_b32 v24, 3, v0
    v_lshl_add_u32 v23, v24, 3, v23
    v_add_u32 v23, 16384, v23
    s_lshl_b32 s58, s57, 1
    s_add_u32 s59, s58, 0
    v_xor_b32 v24, s59, v22
    v_lshl_add_u32 v10, v24, 6, v23
    v_add_u32 v12, 0x10000, v10
    s_add_u32 s59, s58, 1
    v_xor_b32 v24, s59, v22
    v_lshl_add_u32 v11, v24, 6, v23
    v_add_u32 v13, 0x10000, v11
    s_add_u32 s32, s24, 10485760
    s_addc_u32 s33, s25, 0
    s_mov_b32 s34, 7077888
    s_mov_b32 s35, 0x00020000
    s_mov_b32 s48, s24
    s_mov_b32 s49, s25
    s_mov_b32 s50, 33554432
    s_mov_b32 s51, 0x00020000
    s_lshl_b32 s58, s56, 6
    v_add_u32 v22, s58, v21
    s_lshl_b32 s58, s57, 6
    v_add_u32 v23, s58, v21
    v_lshlrev_b32 v28, 2, v22
    v_add_u32 v28, 156800, v28
    v_lshlrev_b32 v22, 4, v22
    v_add_u32 v22, 152704, v22
    v_add_u32 v25, 512, v22
    v_mov_b32 v26, 157312
    v_cmp_eq_u32 vcc, 0, v20
    s_nop 1
    v_cndmask_b32 v29, v26, v22, vcc
    v_cndmask_b32 v30, v26, v25, vcc
    v_lshlrev_b32 v23, 4, v23
    v_add_u32 v31, 154752, v23
    v_lshlrev_b32 v27, 4, v0
    s_lshl_b32 s58, s62, 2
    s_lshl_b32 s59, s56, 1
    s_add_u32 s58, s58, s59
    s_mul_i32 s58, s58, 108
    s_lshl_b32 s59, s63, 3
    s_add_u32 s58, s58, s59
    s_lshl_b32 s59, s57, 2
    s_add_u32 s58, s58, s59
    s_lshl_b32 s68, s58, 10
    s_add_u32 s69, s68, 110592
    s_mul_i32 s70, s62, 28
    s_lshl_b32 s59, s63, 1
    s_add_u32 s70, s70, s59
    s_add_u32 s70, s70, s57
    s_lshl_b32 s70, s70, 1
    s_add_u32 s70, s70, s56
    s_lshl_b32 s70, s70, 4
    s_add_u32 s70, s70, 786432
    s_mov_b32 s66, 0xc0135761
    s_mov_b32 s67, 0xc0135761
    s_barrier
    ds_read_b128 v[32:35], v2 offset:0
    ds_read_b128 v[36:39], v2 offset:4096
    ds_read_b64_tr_b16 v[40:41], v10 offset:0
    ds_read_b64_tr_b16 v[42:43], v10 offset:1024
    ds_read_b64_tr_b16 v[44:45], v11 offset:0
    ds_read_b64_tr_b16 v[46:47], v11 offset:1024
    s_waitcnt lgkmcnt(0)
    v_mfma_f32_32x32x16_bf16 v[64:79], v[40:43], v[32:35], 0
    ds_read_b128 v[48:51], v3 offset:0
    ds_read_b128 v[52:55], v3 offset:4096
    ds_read_b64_tr_b16 v[56:57], v10 offset:4096
    v_mfma_f32_32x32x16_bf16 v[80:95], v[40:43], v[36:39], 0
    ds_read_b64_tr_b16 v[58:59], v10 offset:5120
    ds_read_b64_tr_b16 v[60:61], v11 offset:4096
    ds_read_b64_tr_b16 v[62:63], v11 offset:5120
    v_mfma_f32_32x32x16_bf16 v[96:111], v[44:47], v[32:35], 0
    v_mfma_f32_32x32x16_bf16 v[112:127], v[44:47], v[36:39], 0
    s_waitcnt lgkmcnt(0)
    v_mfma_f32_32x32x16_bf16 v[64:79], v[56:59], v[48:51], v[64:79]
    ds_read_b128 v[32:35], v4 offset:0
    ds_read_b128 v[36:39], v4 offset:4096
    ds_read_b64_tr_b16 v[40:41], v10 offset:8192
    v_mfma_f32_32x32x16_bf16 v[80:95], v[56:59], v[52:55], v[80:95]
    ds_read_b64_tr_b16 v[42:43], v10 offset:9216
    ds_read_b64_tr_b16 v[44:45], v11 offset:8192
    ds_read_b64_tr_b16 v[46:47], v11 offset:9216
    v_mfma_f32_32x32x16_bf16 v[96:111], v[60:63], v[48:51], v[96:111]
    v_mfma_f32_32x32x16_bf16 v[112:127], v[60:63], v[52:55], v[112:127]
    s_waitcnt lgkmcnt(0)
    v_mfma_f32_32x32x16_bf16 v[64:79], v[40:43], v[32:35], v[64:79]
    ds_read_b128 v[48:51], v5 offset:0
    ds_read_b128 v[52:55], v5 offset:4096
    ds_read_b64_tr_b16 v[56:57], v10 offset:12288
    v_mfma_f32_32x32x16_bf16 v[80:95], v[40:43], v[36:39], v[80:95]
    ds_read_b64_tr_b16 v[58:59], v10 offset:13312
    ds_read_b64_tr_b16 v[60:61], v11 offset:12288
    ds_read_b64_tr_b16 v[62:63], v11 offset:13312
    v_mfma_f32_32x32x16_bf16 v[96:111], v[44:47], v[32:35], v[96:111]
    v_mfma_f32_32x32x16_bf16 v[112:127], v[44:47], v[36:39], v[112:127]
    s_waitcnt lgkmcnt(0)
    s_barrier
    v_mfma_f32_32x32x16_bf16 v[64:79], v[56:59], v[48:51], v[64:79]
    ds_read_b128 v[32:35], v2 offset:32768
    ds_read_b128 v[36:39], v2 offset:36864
    ds_read_b64_tr_b16 v[40:41], v10 offset:32768
    v_mfma_f32_32x32x16_bf16 v[80:95], v[56:59], v[52:55], v[80:95]
    ds_read_b64_tr_b16 v[42:43], v10 offset:33792
    ds_read_b64_tr_b16 v[44:45], v11 offset:32768
    ds_read_b64_tr_b16 v[46:47], v11 offset:33792
    v_mfma_f32_32x32x16_bf16 v[96:111], v[60:63], v[48:51], v[96:111]
    v_mfma_f32_32x32x16_bf16 v[112:127], v[60:63], v[52:55], v[112:127]
    s_waitcnt lgkmcnt(0)
    v_mfma_f32_32x32x16_bf16 v[64:79], v[40:43], v[32:35], v[64:79]
    ds_read_b128 v[48:51], v3 offset:32768
    ds_read_b128 v[52:55], v3 offset:36864
    ds_read_b64_tr_b16 v[56:57], v10 offset:36864
    v_mfma_f32_32x32x16_bf16 v[80:95], v[40:43], v[36:39], v[80:95]
    ds_read_b64_tr_b16 v[58:59], v10 offset:37888
    ds_read_b64_tr_b16 v[60:61], v11 offset:36864
    ds_read_b64_tr_b16 v[62:63], v11 offset:37888
    v_mfma_f32_32x32x16_bf16 v[96:111], v[44:47], v[32:35], v[96:111]
    v_mfma_f32_32x32x16_bf16 v[112:127], v[44:47], v[36:39], v[112:127]
    s_waitcnt lgkmcnt(0)
    v_mfma_f32_32x32x16_bf16 v[64:79], v[56:59], v[48:51], v[64:79]
    ds_read_b128 v[32:35], v4 offset:32768
    ds_read_b128 v[36:39], v4 offset:36864
    ds_read_b64_tr_b16 v[40:41], v10 offset:40960
    v_mfma_f32_32x32x16_bf16 v[80:95], v[56:59], v[52:55], v[80:95]
    ds_read_b64_tr_b16 v[42:43], v10 offset:41984
    ds_read_b64_tr_b16 v[44:45], v11 offset:40960
    ds_read_b64_tr_b16 v[46:47], v11 offset:41984
    v_mfma_f32_32x32x16_bf16 v[96:111], v[60:63], v[48:51], v[96:111]
    v_mfma_f32_32x32x16_bf16 v[112:127], v[60:63], v[52:55], v[112:127]
    s_waitcnt lgkmcnt(0)
    v_mfma_f32_32x32x16_bf16 v[64:79], v[40:43], v[32:35], v[64:79]
    ds_read_b128 v[48:51], v5 offset:32768
    ds_read_b128 v[52:55], v5 offset:36864
    ds_read_b64_tr_b16 v[56:57], v10 offset:45056
    v_mfma_f32_32x32x16_bf16 v[80:95], v[40:43], v[36:39], v[80:95]
    ds_read_b64_tr_b16 v[58:59], v10 offset:46080
    ds_read_b64_tr_b16 v[60:61], v11 offset:45056
    ds_read_b64_tr_b16 v[62:63], v11 offset:46080
    v_mfma_f32_32x32x16_bf16 v[96:111], v[44:47], v[32:35], v[96:111]
    v_mfma_f32_32x32x16_bf16 v[112:127], v[44:47], v[36:39], v[112:127]
    s_waitcnt lgkmcnt(0)
    s_barrier
    v_mfma_f32_32x32x16_bf16 v[64:79], v[56:59], v[48:51], v[64:79]
    ds_read_b128 v[32:35], v6 offset:0
    ds_read_b128 v[36:39], v6 offset:4096
    ds_read_b64_tr_b16 v[40:41], v12 offset:0
    v_mfma_f32_32x32x16_bf16 v[80:95], v[56:59], v[52:55], v[80:95]
    ds_read_b64_tr_b16 v[42:43], v12 offset:1024
    ds_read_b64_tr_b16 v[44:45], v13 offset:0
    ds_read_b64_tr_b16 v[46:47], v13 offset:1024
    v_mfma_f32_32x32x16_bf16 v[96:111], v[60:63], v[48:51], v[96:111]
    v_mfma_f32_32x32x16_bf16 v[112:127], v[60:63], v[52:55], v[112:127]
    s_waitcnt lgkmcnt(0)
    v_mfma_f32_32x32x16_bf16 v[64:79], v[40:43], v[32:35], v[64:79]
    ds_read_b128 v[48:51], v7 offset:0
    ds_read_b128 v[52:55], v7 offset:4096
    ds_read_b64_tr_b16 v[56:57], v12 offset:4096
    v_mfma_f32_32x32x16_bf16 v[80:95], v[40:43], v[36:39], v[80:95]
    ds_read_b64_tr_b16 v[58:59], v12 offset:5120
    ds_read_b64_tr_b16 v[60:61], v13 offset:4096
    ds_read_b64_tr_b16 v[62:63], v13 offset:5120
    v_mfma_f32_32x32x16_bf16 v[96:111], v[44:47], v[32:35], v[96:111]
    v_mfma_f32_32x32x16_bf16 v[112:127], v[44:47], v[36:39], v[112:127]
    s_waitcnt lgkmcnt(0)
    v_mfma_f32_32x32x16_bf16 v[64:79], v[56:59], v[48:51], v[64:79]
    ds_read_b128 v[32:35], v8 offset:0
    ds_read_b128 v[36:39], v8 offset:4096
    ds_read_b64_tr_b16 v[40:41], v12 offset:8192
    v_mfma_f32_32x32x16_bf16 v[80:95], v[56:59], v[52:55], v[80:95]
    ds_read_b64_tr_b16 v[42:43], v12 offset:9216
    ds_read_b64_tr_b16 v[44:45], v13 offset:8192
    ds_read_b64_tr_b16 v[46:47], v13 offset:9216
    v_mfma_f32_32x32x16_bf16 v[96:111], v[60:63], v[48:51], v[96:111]
    v_mfma_f32_32x32x16_bf16 v[112:127], v[60:63], v[52:55], v[112:127]
    s_waitcnt lgkmcnt(0)
    v_mfma_f32_32x32x16_bf16 v[64:79], v[40:43], v[32:35], v[64:79]
    ds_read_b128 v[48:51], v9 offset:0
    ds_read_b128 v[52:55], v9 offset:4096
    ds_read_b64_tr_b16 v[56:57], v12 offset:12288
    v_mfma_f32_32x32x16_bf16 v[80:95], v[40:43], v[36:39], v[80:95]
    ds_read_b64_tr_b16 v[58:59], v12 offset:13312
    ds_read_b64_tr_b16 v[60:61], v13 offset:12288
    ds_read_b64_tr_b16 v[62:63], v13 offset:13312
    v_mfma_f32_32x32x16_bf16 v[96:111], v[44:47], v[32:35], v[96:111]
    v_mfma_f32_32x32x16_bf16 v[112:127], v[44:47], v[36:39], v[112:127]
    s_waitcnt lgkmcnt(0)
    s_barrier
    v_mfma_f32_32x32x16_bf16 v[64:79], v[56:59], v[48:51], v[64:79]
    ds_read_b128 v[32:35], v6 offset:32768
    ds_read_b128 v[36:39], v6 offset:36864
    ds_read_b64_tr_b16 v[40:41], v12 offset:32768
    v_mfma_f32_32x32x16_bf16 v[80:95], v[56:59], v[52:55], v[80:95]
    ds_read_b64_tr_b16 v[42:43], v12 offset:33792
    ds_read_b64_tr_b16 v[44:45], v13 offset:32768
    ds_read_b64_tr_b16 v[46:47], v13 offset:33792
    v_mfma_f32_32x32x16_bf16 v[96:111], v[60:63], v[48:51], v[96:111]
    v_mfma_f32_32x32x16_bf16 v[112:127], v[60:63], v[52:55], v[112:127]
    s_waitcnt lgkmcnt(0)
    v_mfma_f32_32x32x16_bf16 v[64:79], v[40:43], v[32:35], v[64:79]
    ds_read_b128 v[48:51], v7 offset:32768
    ds_read_b128 v[52:55], v7 offset:36864
    ds_read_b64_tr_b16 v[56:57], v12 offset:36864
    v_mfma_f32_32x32x16_bf16 v[80:95], v[40:43], v[36:39], v[80:95]
    ds_read_b64_tr_b16 v[58:59], v12 offset:37888
    ds_read_b64_tr_b16 v[60:61], v13 offset:36864
    ds_read_b64_tr_b16 v[62:63], v13 offset:37888
    v_mfma_f32_32x32x16_bf16 v[96:111], v[44:47], v[32:35], v[96:111]
    v_mfma_f32_32x32x16_bf16 v[112:127], v[44:47], v[36:39], v[112:127]
    s_waitcnt lgkmcnt(0)
    v_mfma_f32_32x32x16_bf16 v[64:79], v[56:59], v[48:51], v[64:79]
    ds_read_b128 v[32:35], v8 offset:32768
    ds_read_b128 v[36:39], v8 offset:36864
    ds_read_b64_tr_b16 v[40:41], v12 offset:40960
    v_mfma_f32_32x32x16_bf16 v[80:95], v[56:59], v[52:55], v[80:95]
    ds_read_b64_tr_b16 v[42:43], v12 offset:41984
    ds_read_b64_tr_b16 v[44:45], v13 offset:40960
    ds_read_b64_tr_b16 v[46:47], v13 offset:41984
    v_mfma_f32_32x32x16_bf16 v[96:111], v[60:63], v[48:51], v[96:111]
    v_mfma_f32_32x32x16_bf16 v[112:127], v[60:63], v[52:55], v[112:127]
    s_waitcnt lgkmcnt(0)
    v_mfma_f32_32x32x16_bf16 v[64:79], v[40:43], v[32:35], v[64:79]
    ds_read_b128 v[48:51], v9 offset:32768
    ds_read_b128 v[52:55], v9 offset:36864
    ds_read_b64_tr_b16 v[56:57], v12 offset:45056
    v_mfma_f32_32x32x16_bf16 v[80:95], v[40:43], v[36:39], v[80:95]
    ds_read_b64_tr_b16 v[58:59], v12 offset:46080
    ds_read_b64_tr_b16 v[60:61], v13 offset:45056
    ds_read_b64_tr_b16 v[62:63], v13 offset:46080
    v_mfma_f32_32x32x16_bf16 v[96:111], v[44:47], v[32:35], v[96:111]
    v_mfma_f32_32x32x16_bf16 v[112:127], v[44:47], v[36:39], v[112:127]
    s_waitcnt lgkmcnt(0)
    s_barrier
    v_mfma_f32_32x32x16_bf16 v[64:79], v[56:59], v[48:51], v[64:79]
    ds_read_b128 v[32:35], v2 offset:0
    ds_read_b128 v[36:39], v2 offset:4096
    ds_read_b64_tr_b16 v[40:41], v10 offset:0
    v_mfma_f32_32x32x16_bf16 v[80:95], v[56:59], v[52:55], v[80:95]
    ds_read_b64_tr_b16 v[42:43], v10 offset:1024
    ds_read_b64_tr_b16 v[44:45], v11 offset:0
    ds_read_b64_tr_b16 v[46:47], v11 offset:1024
    v_mfma_f32_32x32x16_bf16 v[96:111], v[60:63], v[48:51], v[96:111]
    v_mfma_f32_32x32x16_bf16 v[112:127], v[60:63], v[52:55], v[112:127]
    s_waitcnt lgkmcnt(0)
    v_mfma_f32_32x32x16_bf16 v[64:79], v[40:43], v[32:35], v[64:79]
    ds_read_b128 v[48:51], v3 offset:0
    ds_read_b128 v[52:55], v3 offset:4096
    ds_read_b64_tr_b16 v[56:57], v10 offset:4096
    v_mfma_f32_32x32x16_bf16 v[80:95], v[40:43], v[36:39], v[80:95]
    ds_read_b64_tr_b16 v[58:59], v10 offset:5120
    ds_read_b64_tr_b16 v[60:61], v11 offset:4096
    ds_read_b64_tr_b16 v[62:63], v11 offset:5120
    v_mfma_f32_32x32x16_bf16 v[96:111], v[44:47], v[32:35], v[96:111]
    v_mfma_f32_32x32x16_bf16 v[112:127], v[44:47], v[36:39], v[112:127]
    s_waitcnt lgkmcnt(0)
    v_mfma_f32_32x32x16_bf16 v[64:79], v[56:59], v[48:51], v[64:79]
    ds_read_b128 v[32:35], v4 offset:0
    ds_read_b128 v[36:39], v4 offset:4096
    ds_read_b64_tr_b16 v[40:41], v10 offset:8192
    v_mfma_f32_32x32x16_bf16 v[80:95], v[56:59], v[52:55], v[80:95]
    ds_read_b64_tr_b16 v[42:43], v10 offset:9216
    ds_read_b64_tr_b16 v[44:45], v11 offset:8192
    ds_read_b64_tr_b16 v[46:47], v11 offset:9216
    v_mfma_f32_32x32x16_bf16 v[96:111], v[60:63], v[48:51], v[96:111]
    v_mfma_f32_32x32x16_bf16 v[112:127], v[60:63], v[52:55], v[112:127]
    s_waitcnt lgkmcnt(0)
    v_mfma_f32_32x32x16_bf16 v[64:79], v[40:43], v[32:35], v[64:79]
    ds_read_b128 v[48:51], v5 offset:0
    ds_read_b128 v[52:55], v5 offset:4096
    ds_read_b64_tr_b16 v[56:57], v10 offset:12288
    v_mfma_f32_32x32x16_bf16 v[80:95], v[40:43], v[36:39], v[80:95]
    ds_read_b64_tr_b16 v[58:59], v10 offset:13312
    ds_read_b64_tr_b16 v[60:61], v11 offset:12288
    ds_read_b64_tr_b16 v[62:63], v11 offset:13312
    v_mfma_f32_32x32x16_bf16 v[96:111], v[44:47], v[32:35], v[96:111]
    v_mfma_f32_32x32x16_bf16 v[112:127], v[44:47], v[36:39], v[112:127]
    s_waitcnt lgkmcnt(0)
    s_barrier
    v_mfma_f32_32x32x16_bf16 v[64:79], v[56:59], v[48:51], v[64:79]
    ds_read_b128 v[32:35], v2 offset:32768
    ds_read_b128 v[36:39], v2 offset:36864
    ds_read_b64_tr_b16 v[40:41], v10 offset:32768
    v_mfma_f32_32x32x16_bf16 v[80:95], v[56:59], v[52:55], v[80:95]
    ds_read_b64_tr_b16 v[42:43], v10 offset:33792
    ds_read_b64_tr_b16 v[44:45], v11 offset:32768
    ds_read_b64_tr_b16 v[46:47], v11 offset:33792
    v_mfma_f32_32x32x16_bf16 v[96:111], v[60:63], v[48:51], v[96:111]
    v_mfma_f32_32x32x16_bf16 v[112:127], v[60:63], v[52:55], v[112:127]
    s_waitcnt lgkmcnt(0)
    v_mfma_f32_32x32x16_bf16 v[64:79], v[40:43], v[32:35], v[64:79]
    ds_read_b128 v[48:51], v3 offset:32768
    ds_read_b128 v[52:55], v3 offset:36864
    ds_read_b64_tr_b16 v[56:57], v10 offset:36864
    v_mfma_f32_32x32x16_bf16 v[80:95], v[40:43], v[36:39], v[80:95]
    ds_read_b64_tr_b16 v[58:59], v10 offset:37888
    ds_read_b64_tr_b16 v[60:61], v11 offset:36864
    ds_read_b64_tr_b16 v[62:63], v11 offset:37888
    v_mfma_f32_32x32x16_bf16 v[96:111], v[44:47], v[32:35], v[96:111]
    v_mfma_f32_32x32x16_bf16 v[112:127], v[44:47], v[36:39], v[112:127]
    s_waitcnt lgkmcnt(0)
    v_mfma_f32_32x32x16_bf16 v[64:79], v[56:59], v[48:51], v[64:79]
    ds_read_b128 v[32:35], v4 offset:32768
    ds_read_b128 v[36:39], v4 offset:36864
    ds_read_b64_tr_b16 v[40:41], v10 offset:40960
    v_mfma_f32_32x32x16_bf16 v[80:95], v[56:59], v[52:55], v[80:95]
    ds_read_b64_tr_b16 v[42:43], v10 offset:41984
    ds_read_b64_tr_b16 v[44:45], v11 offset:40960
    ds_read_b64_tr_b16 v[46:47], v11 offset:41984
    v_mfma_f32_32x32x16_bf16 v[96:111], v[60:63], v[48:51], v[96:111]
    v_mfma_f32_32x32x16_bf16 v[112:127], v[60:63], v[52:55], v[112:127]
    s_waitcnt lgkmcnt(0)
    v_mfma_f32_32x32x16_bf16 v[64:79], v[40:43], v[32:35], v[64:79]
    ds_read_b128 v[48:51], v5 offset:32768
    ds_read_b128 v[52:55], v5 offset:36864
    ds_read_b64_tr_b16 v[56:57], v10 offset:45056
    v_mfma_f32_32x32x16_bf16 v[80:95], v[40:43], v[36:39], v[80:95]
    ds_read_b64_tr_b16 v[58:59], v10 offset:46080
    ds_read_b64_tr_b16 v[60:61], v11 offset:45056
    ds_read_b64_tr_b16 v[62:63], v11 offset:46080
    v_mfma_f32_32x32x16_bf16 v[96:111], v[44:47], v[32:35], v[96:111]
    v_mfma_f32_32x32x16_bf16 v[112:127], v[44:47], v[36:39], v[112:127]
    s_waitcnt lgkmcnt(0)
    s_barrier
    v_mfma_f32_32x32x16_bf16 v[64:79], v[56:59], v[48:51], v[64:79]
    ds_read_b128 v[32:35], v6 offset:0
    ds_read_b128 v[36:39], v6 offset:4096
    ds_read_b64_tr_b16 v[40:41], v12 offset:0
    v_mfma_f32_32x32x16_bf16 v[80:95], v[56:59], v[52:55], v[80:95]
    ds_read_b64_tr_b16 v[42:43], v12 offset:1024
    ds_read_b64_tr_b16 v[44:45], v13 offset:0
    ds_read_b64_tr_b16 v[46:47], v13 offset:1024
    v_mfma_f32_32x32x16_bf16 v[96:111], v[60:63], v[48:51], v[96:111]
    v_mfma_f32_32x32x16_bf16 v[112:127], v[60:63], v[52:55], v[112:127]
    s_waitcnt lgkmcnt(0)
    v_mfma_f32_32x32x16_bf16 v[64:79], v[40:43], v[32:35], v[64:79]
    ds_read_b128 v[48:51], v7 offset:0
    ds_read_b128 v[52:55], v7 offset:4096
    ds_read_b64_tr_b16 v[56:57], v12 offset:4096
    v_mfma_f32_32x32x16_bf16 v[80:95], v[40:43], v[36:39], v[80:95]
    ds_read_b64_tr_b16 v[58:59], v12 offset:5120
    ds_read_b64_tr_b16 v[60:61], v13 offset:4096
    ds_read_b64_tr_b16 v[62:63], v13 offset:5120
    v_mfma_f32_32x32x16_bf16 v[96:111], v[44:47], v[32:35], v[96:111]
    v_mfma_f32_32x32x16_bf16 v[112:127], v[44:47], v[36:39], v[112:127]
    s_waitcnt lgkmcnt(0)
    v_mfma_f32_32x32x16_bf16 v[64:79], v[56:59], v[48:51], v[64:79]
    ds_read_b128 v[32:35], v8 offset:0
    ds_read_b128 v[36:39], v8 offset:4096
    ds_read_b64_tr_b16 v[40:41], v12 offset:8192
    v_mfma_f32_32x32x16_bf16 v[80:95], v[56:59], v[52:55], v[80:95]
    ds_read_b64_tr_b16 v[42:43], v12 offset:9216
    ds_read_b64_tr_b16 v[44:45], v13 offset:8192
    ds_read_b64_tr_b16 v[46:47], v13 offset:9216
    v_mfma_f32_32x32x16_bf16 v[96:111], v[60:63], v[48:51], v[96:111]
    v_mfma_f32_32x32x16_bf16 v[112:127], v[60:63], v[52:55], v[112:127]
    s_waitcnt lgkmcnt(0)
    v_mfma_f32_32x32x16_bf16 v[64:79], v[40:43], v[32:35], v[64:79]
    ds_read_b128 v[48:51], v9 offset:0
    ds_read_b128 v[52:55], v9 offset:4096
    ds_read_b64_tr_b16 v[56:57], v12 offset:12288
    v_mfma_f32_32x32x16_bf16 v[80:95], v[40:43], v[36:39], v[80:95]
    ds_read_b64_tr_b16 v[58:59], v12 offset:13312
    ds_read_b64_tr_b16 v[60:61], v13 offset:12288
    ds_read_b64_tr_b16 v[62:63], v13 offset:13312
    v_mfma_f32_32x32x16_bf16 v[96:111], v[44:47], v[32:35], v[96:111]
    v_mfma_f32_32x32x16_bf16 v[112:127], v[44:47], v[36:39], v[112:127]
    s_waitcnt lgkmcnt(0)
    s_barrier
    v_mfma_f32_32x32x16_bf16 v[64:79], v[56:59], v[48:51], v[64:79]
    ds_read_b128 v[32:35], v6 offset:32768
    ds_read_b128 v[36:39], v6 offset:36864
    ds_read_b64_tr_b16 v[40:41], v12 offset:32768
    v_mfma_f32_32x32x16_bf16 v[80:95], v[56:59], v[52:55], v[80:95]
    ds_read_b64_tr_b16 v[42:43], v12 offset:33792
    ds_read_b64_tr_b16 v[44:45], v13 offset:32768
    ds_read_b64_tr_b16 v[46:47], v13 offset:33792
    v_mfma_f32_32x32x16_bf16 v[96:111], v[60:63], v[48:51], v[96:111]
    v_mfma_f32_32x32x16_bf16 v[112:127], v[60:63], v[52:55], v[112:127]
    s_waitcnt lgkmcnt(0)
    v_mfma_f32_32x32x16_bf16 v[64:79], v[40:43], v[32:35], v[64:79]
    ds_read_b128 v[48:51], v7 offset:32768
    ds_read_b128 v[52:55], v7 offset:36864
    ds_read_b64_tr_b16 v[56:57], v12 offset:36864
    v_mfma_f32_32x32x16_bf16 v[80:95], v[40:43], v[36:39], v[80:95]
    ds_read_b64_tr_b16 v[58:59], v12 offset:37888
    ds_read_b64_tr_b16 v[60:61], v13 offset:36864
    ds_read_b64_tr_b16 v[62:63], v13 offset:37888
    v_mfma_f32_32x32x16_bf16 v[96:111], v[44:47], v[32:35], v[96:111]
    v_mfma_f32_32x32x16_bf16 v[112:127], v[44:47], v[36:39], v[112:127]
    s_waitcnt lgkmcnt(0)
    v_mfma_f32_32x32x16_bf16 v[64:79], v[56:59], v[48:51], v[64:79]
    ds_read_b128 v[32:35], v8 offset:32768
    ds_read_b128 v[36:39], v8 offset:36864
    ds_read_b64_tr_b16 v[40:41], v12 offset:40960
    v_mfma_f32_32x32x16_bf16 v[80:95], v[56:59], v[52:55], v[80:95]
    ds_read_b64_tr_b16 v[42:43], v12 offset:41984
    ds_read_b64_tr_b16 v[44:45], v13 offset:40960
    ds_read_b64_tr_b16 v[46:47], v13 offset:41984
    v_mfma_f32_32x32x16_bf16 v[96:111], v[60:63], v[48:51], v[96:111]
    v_mfma_f32_32x32x16_bf16 v[112:127], v[60:63], v[52:55], v[112:127]
    s_waitcnt lgkmcnt(0)
    v_mfma_f32_32x32x16_bf16 v[64:79], v[40:43], v[32:35], v[64:79]
    ds_read_b128 v[48:51], v9 offset:32768
    ds_read_b128 v[52:55], v9 offset:36864
    ds_read_b64_tr_b16 v[56:57], v12 offset:45056
    v_mfma_f32_32x32x16_bf16 v[80:95], v[40:43], v[36:39], v[80:95]
    ds_read_b64_tr_b16 v[58:59], v12 offset:46080
    ds_read_b64_tr_b16 v[60:61], v13 offset:45056
    ds_read_b64_tr_b16 v[62:63], v13 offset:46080
    v_mfma_f32_32x32x16_bf16 v[96:111], v[44:47], v[32:35], v[96:111]
    v_mfma_f32_32x32x16_bf16 v[112:127], v[44:47], v[36:39], v[112:127]
    s_waitcnt lgkmcnt(0)
    v_mfma_f32_32x32x16_bf16 v[64:79], v[56:59], v[48:51], v[64:79]
    ds_read_b128 v[32:35], v2 offset:0
    ds_read_b128 v[36:39], v2 offset:4096
    ds_read_b64_tr_b16 v[40:41], v10 offset:0
    v_mfma_f32_32x32x16_bf16 v[80:95], v[56:59], v[52:55], v[80:95]
    ds_read_b64_tr_b16 v[42:43], v10 offset:1024
    ds_read_b64_tr_b16 v[44:45], v11 offset:0
    ds_read_b64_tr_b16 v[46:47], v11 offset:1024
    v_mfma_f32_32x32x16_bf16 v[96:111], v[60:63], v[48:51], v[96:111]
    v_mfma_f32_32x32x16_bf16 v[112:127], v[60:63], v[52:55], v[112:127]
    s_waitcnt lgkmcnt(0)
    v_mfma_f32_32x32x16_bf16 v[64:79], v[40:43], v[32:35], v[64:79]
    ds_read_b128 v[48:51], v3 offset:0
    ds_read_b128 v[52:55], v3 offset:4096
    ds_read_b64_tr_b16 v[56:57], v10 offset:4096
    v_mfma_f32_32x32x16_bf16 v[80:95], v[40:43], v[36:39], v[80:95]
    ds_read_b64_tr_b16 v[58:59], v10 offset:5120
    ds_read_b64_tr_b16 v[60:61], v11 offset:4096
    ds_read_b64_tr_b16 v[62:63], v11 offset:5120
    v_mfma_f32_32x32x16_bf16 v[96:111], v[44:47], v[32:35], v[96:111]
    v_mfma_f32_32x32x16_bf16 v[112:127], v[44:47], v[36:39], v[112:127]
    s_waitcnt lgkmcnt(0)
    v_mfma_f32_32x32x16_bf16 v[64:79], v[56:59], v[48:51], v[64:79]
    ds_read_b128 v[32:35], v4 offset:0
    ds_read_b128 v[36:39], v4 offset:4096
    ds_read_b64_tr_b16 v[40:41], v10 offset:8192
    v_mfma_f32_32x32x16_bf16 v[80:95], v[56:59], v[52:55], v[80:95]
    ds_read_b64_tr_b16 v[42:43], v10 offset:9216
    ds_read_b64_tr_b16 v[44:45], v11 offset:8192
    ds_read_b64_tr_b16 v[46:47], v11 offset:9216
    v_mfma_f32_32x32x16_bf16 v[96:111], v[60:63], v[48:51], v[96:111]
    v_mfma_f32_32x32x16_bf16 v[112:127], v[60:63], v[52:55], v[112:127]
    s_waitcnt lgkmcnt(0)
    v_mfma_f32_32x32x16_bf16 v[64:79], v[40:43], v[32:35], v[64:79]
    ds_read_b128 v[48:51], v5 offset:0
    ds_read_b128 v[52:55], v5 offset:4096
    ds_read_b64_tr_b16 v[56:57], v10 offset:12288
    v_mfma_f32_32x32x16_bf16 v[80:95], v[40:43], v[36:39], v[80:95]
    ds_read_b64_tr_b16 v[58:59], v10 offset:13312
    ds_read_b64_tr_b16 v[60:61], v11 offset:12288
    ds_read_b64_tr_b16 v[62:63], v11 offset:13312
    v_mfma_f32_32x32x16_bf16 v[96:111], v[44:47], v[32:35], v[96:111]
    v_mfma_f32_32x32x16_bf16 v[112:127], v[44:47], v[36:39], v[112:127]
    s_waitcnt lgkmcnt(0)
    v_mfma_f32_32x32x16_bf16 v[64:79], v[56:59], v[48:51], v[64:79]
    ds_read_b128 v[32:35], v2 offset:32768
    ds_read_b128 v[36:39], v2 offset:36864
    ds_read_b64_tr_b16 v[40:41], v10 offset:32768
    v_mfma_f32_32x32x16_bf16 v[80:95], v[56:59], v[52:55], v[80:95]
    ds_read_b64_tr_b16 v[42:43], v10 offset:33792
    ds_read_b64_tr_b16 v[44:45], v11 offset:32768
    ds_read_b64_tr_b16 v[46:47], v11 offset:33792
    v_mfma_f32_32x32x16_bf16 v[96:111], v[60:63], v[48:51], v[96:111]
    v_mfma_f32_32x32x16_bf16 v[112:127], v[60:63], v[52:55], v[112:127]
    s_waitcnt lgkmcnt(0)
    v_mfma_f32_32x32x16_bf16 v[64:79], v[40:43], v[32:35], v[64:79]
    ds_read_b128 v[48:51], v3 offset:32768
    ds_read_b128 v[52:55], v3 offset:36864
    ds_read_b64_tr_b16 v[56:57], v10 offset:36864
    v_mfma_f32_32x32x16_bf16 v[80:95], v[40:43], v[36:39], v[80:95]
    ds_read_b64_tr_b16 v[58:59], v10 offset:37888
    ds_read_b64_tr_b16 v[60:61], v11 offset:36864
    ds_read_b64_tr_b16 v[62:63], v11 offset:37888
    v_mfma_f32_32x32x16_bf16 v[96:111], v[44:47], v[32:35], v[96:111]
    v_mfma_f32_32x32x16_bf16 v[112:127], v[44:47], v[36:39], v[112:127]
    s_waitcnt lgkmcnt(0)
    v_mfma_f32_32x32x16_bf16 v[64:79], v[56:59], v[48:51], v[64:79]
    ds_read_b128 v[32:35], v4 offset:32768
    ds_read_b128 v[36:39], v4 offset:36864
    ds_read_b64_tr_b16 v[40:41], v10 offset:40960
    v_mfma_f32_32x32x16_bf16 v[80:95], v[56:59], v[52:55], v[80:95]
    ds_read_b64_tr_b16 v[42:43], v10 offset:41984
    ds_read_b64_tr_b16 v[44:45], v11 offset:40960
    ds_read_b64_tr_b16 v[46:47], v11 offset:41984
    v_mfma_f32_32x32x16_bf16 v[96:111], v[60:63], v[48:51], v[96:111]
    v_mfma_f32_32x32x16_bf16 v[112:127], v[60:63], v[52:55], v[112:127]
    s_waitcnt lgkmcnt(0)
    v_mfma_f32_32x32x16_bf16 v[64:79], v[40:43], v[32:35], v[64:79]
    ds_read_b128 v[48:51], v5 offset:32768
    ds_read_b128 v[52:55], v5 offset:36864
    ds_read_b64_tr_b16 v[56:57], v10 offset:45056
    v_mfma_f32_32x32x16_bf16 v[80:95], v[40:43], v[36:39], v[80:95]
    ds_read_b64_tr_b16 v[58:59], v10 offset:46080
    ds_read_b64_tr_b16 v[60:61], v11 offset:45056
    ds_read_b64_tr_b16 v[62:63], v11 offset:46080
    v_mfma_f32_32x32x16_bf16 v[96:111], v[44:47], v[32:35], v[96:111]
    v_mfma_f32_32x32x16_bf16 v[112:127], v[44:47], v[36:39], v[112:127]
    s_waitcnt lgkmcnt(0)
    v_mfma_f32_32x32x16_bf16 v[64:79], v[56:59], v[48:51], v[64:79]
    v_mfma_f32_32x32x16_bf16 v[80:95], v[56:59], v[52:55], v[80:95]
    v_mfma_f32_32x32x16_bf16 v[96:111], v[60:63], v[48:51], v[96:111]
    v_mfma_f32_32x32x16_bf16 v[112:127], v[60:63], v[52:55], v[112:127]
    s_setprio 3
    s_lshl_b32 s58, s26, 2
    s_add_u32 s58, s58, 157440
    v_mov_b32 v20, s58
    v_mov_b32 v21, 1
    ds_write_b32 v20, v21
    v_mov_b32 v20, 157584
    ds_read_b32 v21, v20
    s_waitcnt lgkmcnt(0)
    v_readfirstlane_b32 s27, v21
    s_cmp_eq_u32 s63, 13
    s_cselect_b32 s58, s57, 0
    s_cmp_lg_u32 s58, 0
    s_cbranch_scc1 Lc2
    v_mov_b32 v24, 157344
    s_mov_b32 s30, 0
Lfw_1:
    ds_read_b128 v[20:23], v24
    s_waitcnt lgkmcnt(0)
    v_and_b32 v20, v20, v21
    v_and_b32 v22, v22, v23
    v_and_b32 v20, v20, v22
    s_nop 0
    v_readfirstlane_b32 s58, v20
    s_add_u32 s30, s30, 1
    s_cmp_ge_u32 s30, 320000
    s_cselect_b32 s58, 1, s58
    s_cmp_eq_u32 s58, 0
    s_cbranch_scc1 Lfw_1
    ds_read_b32 v16, v28
    ds_read_b32 v18, v28 offset:128
    ds_read_b128 v[32:35], v29
    ds_read_b128 v[36:39], v30
    ds_read_b128 v[40:43], v31
    ds_read_b128 v[44:47], v31 offset:512
    v_mov_b32 v20, 0xbdd2d3e8
    v_mov_b32 v21, 0xbdd2d3e8
    v_mov_b32 v22, 1.0
    v_mov_b32 v23, 1.0
    s_waitcnt lgkmcnt(0)
    v_mfma_f32_32x32x16_bf16 v[64:79], v[40:43], v[32:35], v[64:79]
    v_mfma_f32_32x32x16_bf16 v[80:95], v[40:43], v[36:39], v[80:95]
    v_mfma_f32_32x32x16_bf16 v[96:111], v[44:47], v[32:35], v[96:111]
    v_mfma_f32_32x32x16_bf16 v[112:127], v[44:47], v[36:39], v[112:127]
    s_nop 8
    v_pk_mul_f32 v[128:129], v[64:65], v[16:17] op_sel_hi:[1,0]
    v_pk_mul_f32 v[134:135], v[66:67], v[16:17] op_sel_hi:[1,0]
    v_pk_mul_f32 v[140:141], v[68:69], v[16:17] op_sel_hi:[1,0]
    v_pk_mul_f32 v[146:147], v[70:71], v[16:17] op_sel_hi:[1,0]
    v_pk_mul_f32 v[130:131], v[128:129], v[128:129]
    v_pk_mul_f32 v[136:137], v[134:135], v[134:135]
    v_pk_mul_f32 v[142:143], v[140:141], v[140:141]
    v_pk_mul_f32 v[148:149], v[146:147], v[146:147]
    v_pk_fma_f32 v[130:131], v[130:131], v[20:21], s[66:67]
    v_pk_fma_f32 v[136:137], v[136:137], v[20:21], s[66:67]
    v_pk_fma_f32 v[142:143], v[142:143], v[20:21], s[66:67]
    v_pk_fma_f32 v[148:149], v[148:149], v[20:21], s[66:67]
    v_pk_mul_f32 v[132:133], v[128:129], v[130:131]
    v_pk_mul_f32 v[138:139], v[134:135], v[136:137]
    v_pk_mul_f32 v[144:145], v[140:141], v[142:143]
    v_pk_mul_f32 v[150:151], v[146:147], v[148:149]
    v_exp_f32 v132, v132
    v_exp_f32 v133, v133
    v_exp_f32 v138, v138
    v_exp_f32 v139, v139
    v_exp_f32 v144, v144
    v_exp_f32 v145, v145
    v_exp_f32 v150, v150
    v_exp_f32 v151, v151
    v_pk_add_f32 v[132:133], v[132:133], v[22:23]
    v_pk_add_f32 v[138:139], v[138:139], v[22:23]
    v_pk_add_f32 v[144:145], v[144:145], v[22:23]
    v_pk_add_f32 v[150:151], v[150:151], v[22:23]
    v_rcp_f32 v132, v132
    v_rcp_f32 v133, v133
    v_rcp_f32 v138, v138
    v_rcp_f32 v139, v139
    v_rcp_f32 v144, v144
    v_rcp_f32 v145, v145
    v_rcp_f32 v150, v150
    v_rcp_f32 v151, v151
    v_pk_mul_f32 v[128:129], v[128:129], v[132:133]
    v_pk_mul_f32 v[134:135], v[134:135], v[138:139]
    v_pk_mul_f32 v[140:141], v[140:141], v[144:145]
    v_pk_mul_f32 v[146:147], v[146:147], v[150:151]
    v_cvt_pk_bf16_f32 v152, v128, v129
    v_cvt_pk_bf16_f32 v153, v134, v135
    v_cvt_pk_bf16_f32 v154, v140, v141
    v_cvt_pk_bf16_f32 v155, v146, v147
    buffer_store_dwordx4 v[152:155], v27, s[32:35], s68 offen offset:0 sc1
    v_pk_mul_f32 v[128:129], v[72:73], v[16:17] op_sel_hi:[1,0]
    v_pk_mul_f32 v[134:135], v[74:75], v[16:17] op_sel_hi:[1,0]
    v_pk_mul_f32 v[140:141], v[76:77], v[16:17] op_sel_hi:[1,0]
    v_pk_mul_f32 v[146:147], v[78:79], v[16:17] op_sel_hi:[1,0]
    v_pk_mul_f32 v[130:131], v[128:129], v[128:129]
    v_pk_mul_f32 v[136:137], v[134:135], v[134:135]
    v_pk_mul_f32 v[142:143], v[140:141], v[140:141]
    v_pk_mul_f32 v[148:149], v[146:147], v[146:147]
    v_pk_fma_f32 v[130:131], v[130:131], v[20:21], s[66:67]
    v_pk_fma_f32 v[136:137], v[136:137], v[20:21], s[66:67]
    v_pk_fma_f32 v[142:143], v[142:143], v[20:21], s[66:67]
    v_pk_fma_f32 v[148:149], v[148:149], v[20:21], s[66:67]
    v_pk_mul_f32 v[132:133], v[128:129], v[130:131]
    v_pk_mul_f32 v[138:139], v[134:135], v[136:137]
    v_pk_mul_f32 v[144:145], v[140:141], v[142:143]
    v_pk_mul_f32 v[150:151], v[146:147], v[148:149]
    v_exp_f32 v132, v132
    v_exp_f32 v133, v133
    v_exp_f32 v138, v138
    v_exp_f32 v139, v139
    v_exp_f32 v144, v144
    v_exp_f32 v145, v145
    v_exp_f32 v150, v150
    v_exp_f32 v151, v151
    v_pk_add_f32 v[132:133], v[132:133], v[22:23]
    v_pk_add_f32 v[138:139], v[138:139], v[22:23]
    v_pk_add_f32 v[144:145], v[144:145], v[22:23]
    v_pk_add_f32 v[150:151], v[150:151], v[22:23]
    v_rcp_f32 v132, v132
    v_rcp_f32 v133, v133
    v_rcp_f32 v138, v138
    v_rcp_f32 v139, v139
    v_rcp_f32 v144, v144
    v_rcp_f32 v145, v145
    v_rcp_f32 v150, v150
    v_rcp_f32 v151, v151
    v_pk_mul_f32 v[128:129], v[128:129], v[132:133]
    v_pk_mul_f32 v[134:135], v[134:135], v[138:139]
    v_pk_mul_f32 v[140:141], v[140:141], v[144:145]
    v_pk_mul_f32 v[146:147], v[146:147], v[150:151]
    v_cvt_pk_bf16_f32 v156, v128, v129
    v_cvt_pk_bf16_f32 v157, v134, v135
    v_cvt_pk_bf16_f32 v158, v140, v141
    v_cvt_pk_bf16_f32 v159, v146, v147
    buffer_store_dwordx4 v[156:159], v27, s[32:35], s68 offen offset:1024 sc1
    v_pk_mul_f32 v[128:129], v[80:81], v[18:19] op_sel_hi:[1,0]
    v_pk_mul_f32 v[134:135], v[82:83], v[18:19] op_sel_hi:[1,0]
    v_pk_mul_f32 v[140:141], v[84:85], v[18:19] op_sel_hi:[1,0]
    v_pk_mul_f32 v[146:147], v[86:87], v[18:19] op_sel_hi:[1,0]
    v_pk_mul_f32 v[130:131], v[128:129], v[128:129]
    v_pk_mul_f32 v[136:137], v[134:135], v[134:135]
    v_pk_mul_f32 v[142:143], v[140:141], v[140:141]
    v_pk_mul_f32 v[148:149], v[146:147], v[146:147]
    v_pk_fma_f32 v[130:131], v[130:131], v[20:21], s[66:67]
    v_pk_fma_f32 v[136:137], v[136:137], v[20:21], s[66:67]
    v_pk_fma_f32 v[142:143], v[142:143], v[20:21], s[66:67]
    v_pk_fma_f32 v[148:149], v[148:149], v[20:21], s[66:67]
    v_pk_mul_f32 v[132:133], v[128:129], v[130:131]
    v_pk_mul_f32 v[138:139], v[134:135], v[136:137]
    v_pk_mul_f32 v[144:145], v[140:141], v[142:143]
    v_pk_mul_f32 v[150:151], v[146:147], v[148:149]
    v_exp_f32 v132, v132
    v_exp_f32 v133, v133
    v_exp_f32 v138, v138
    v_exp_f32 v139, v139
    v_exp_f32 v144, v144
    v_exp_f32 v145, v145
    v_exp_f32 v150, v150
    v_exp_f32 v151, v151
    v_pk_add_f32 v[132:133], v[132:133], v[22:23]
    v_pk_add_f32 v[138:139], v[138:139], v[22:23]
    v_pk_add_f32 v[144:145], v[144:145], v[22:23]
    v_pk_add_f32 v[150:151], v[150:151], v[22:23]
    v_rcp_f32 v132, v132
    v_rcp_f32 v133, v133
    v_rcp_f32 v138, v138
    v_rcp_f32 v139, v139
    v_rcp_f32 v144, v144
    v_rcp_f32 v145, v145
    v_rcp_f32 v150, v150
    v_rcp_f32 v151, v151
    v_pk_mul_f32 v[128:129], v[128:129], v[132:133]
    v_pk_mul_f32 v[134:135], v[134:135], v[138:139]
    v_pk_mul_f32 v[140:141], v[140:141], v[144:145]
    v_pk_mul_f32 v[146:147], v[146:147], v[150:151]
    v_cvt_pk_bf16_f32 v160, v128, v129
    v_cvt_pk_bf16_f32 v161, v134, v135
    v_cvt_pk_bf16_f32 v162, v140, v141
    v_cvt_pk_bf16_f32 v163, v146, v147
    buffer_store_dwordx4 v[160:163], v27, s[32:35], s69 offen offset:0 sc1
    v_pk_mul_f32 v[128:129], v[88:89], v[18:19] op_sel_hi:[1,0]
    v_pk_mul_f32 v[134:135], v[90:91], v[18:19] op_sel_hi:[1,0]
    v_pk_mul_f32 v[140:141], v[92:93], v[18:19] op_sel_hi:[1,0]
    v_pk_mul_f32 v[146:147], v[94:95], v[18:19] op_sel_hi:[1,0]
    v_pk_mul_f32 v[130:131], v[128:129], v[128:129]
    v_pk_mul_f32 v[136:137], v[134:135], v[134:135]
    v_pk_mul_f32 v[142:143], v[140:141], v[140:141]
    v_pk_mul_f32 v[148:149], v[146:147], v[146:147]
    v_pk_fma_f32 v[130:131], v[130:131], v[20:21], s[66:67]
    v_pk_fma_f32 v[136:137], v[136:137], v[20:21], s[66:67]
    v_pk_fma_f32 v[142:143], v[142:143], v[20:21], s[66:67]
    v_pk_fma_f32 v[148:149], v[148:149], v[20:21], s[66:67]
    v_pk_mul_f32 v[132:133], v[128:129], v[130:131]
    v_pk_mul_f32 v[138:139], v[134:135], v[136:137]
    v_pk_mul_f32 v[144:145], v[140:141], v[142:143]
    v_pk_mul_f32 v[150:151], v[146:147], v[148:149]
    v_exp_f32 v132, v132
    v_exp_f32 v133, v133
    v_exp_f32 v138, v138
    v_exp_f32 v139, v139
    v_exp_f32 v144, v144
    v_exp_f32 v145, v145
    v_exp_f32 v150, v150
    v_exp_f32 v151, v151
    v_pk_add_f32 v[132:133], v[132:133], v[22:23]
    v_pk_add_f32 v[138:139], v[138:139], v[22:23]
    v_pk_add_f32 v[144:145], v[144:145], v[22:23]
    v_pk_add_f32 v[150:151], v[150:151], v[22:23]
    v_rcp_f32 v132, v132
    v_rcp_f32 v133, v133
    v_rcp_f32 v138, v138
    v_rcp_f32 v139, v139
    v_rcp_f32 v144, v144
    v_rcp_f32 v145, v145
    v_rcp_f32 v150, v150
    v_rcp_f32 v151, v151
    v_pk_mul_f32 v[128:129], v[128:129], v[132:133]
    v_pk_mul_f32 v[134:135], v[134:135], v[138:139]
    v_pk_mul_f32 v[140:141], v[140:141], v[144:145]
    v_pk_mul_f32 v[146:147], v[146:147], v[150:151]
    v_cvt_pk_bf16_f32 v164, v128, v129
    v_cvt_pk_bf16_f32 v165, v134, v135
    v_cvt_pk_bf16_f32 v166, v140, v141
    v_cvt_pk_bf16_f32 v167, v146, v147
    buffer_store_dwordx4 v[164:167], v27, s[32:35], s69 offen offset:1024 sc1
    v_pk_mul_f32 v[128:129], v[96:97], v[16:17] op_sel_hi:[1,0]
    v_pk_mul_f32 v[134:135], v[98:99], v[16:17] op_sel_hi:[1,0]
    v_pk_mul_f32 v[140:141], v[100:101], v[16:17] op_sel_hi:[1,0]
    v_pk_mul_f32 v[146:147], v[102:103], v[16:17] op_sel_hi:[1,0]
    v_pk_mul_f32 v[130:131], v[128:129], v[128:129]
    v_pk_mul_f32 v[136:137], v[134:135], v[134:135]
    v_pk_mul_f32 v[142:143], v[140:141], v[140:141]
    v_pk_mul_f32 v[148:149], v[146:147], v[146:147]
    v_pk_fma_f32 v[130:131], v[130:131], v[20:21], s[66:67]
    v_pk_fma_f32 v[136:137], v[136:137], v[20:21], s[66:67]
    v_pk_fma_f32 v[142:143], v[142:143], v[20:21], s[66:67]
    v_pk_fma_f32 v[148:149], v[148:149], v[20:21], s[66:67]
    v_pk_mul_f32 v[132:133], v[128:129], v[130:131]
    v_pk_mul_f32 v[138:139], v[134:135], v[136:137]
    v_pk_mul_f32 v[144:145], v[140:141], v[142:143]
    v_pk_mul_f32 v[150:151], v[146:147], v[148:149]
    v_exp_f32 v132, v132
    v_exp_f32 v133, v133
    v_exp_f32 v138, v138
    v_exp_f32 v139, v139
    v_exp_f32 v144, v144
    v_exp_f32 v145, v145
    v_exp_f32 v150, v150
    v_exp_f32 v151, v151
    v_pk_add_f32 v[132:133], v[132:133], v[22:23]
    v_pk_add_f32 v[138:139], v[138:139], v[22:23]
    v_pk_add_f32 v[144:145], v[144:145], v[22:23]
    v_pk_add_f32 v[150:151], v[150:151], v[22:23]
    v_rcp_f32 v132, v132
    v_rcp_f32 v133, v133
    v_rcp_f32 v138, v138
    v_rcp_f32 v139, v139
    v_rcp_f32 v144, v144
    v_rcp_f32 v145, v145
    v_rcp_f32 v150, v150
    v_rcp_f32 v151, v151
    v_pk_mul_f32 v[128:129], v[128:129], v[132:133]
    v_pk_mul_f32 v[134:135], v[134:135], v[138:139]
    v_pk_mul_f32 v[140:141], v[140:141], v[144:145]
    v_pk_mul_f32 v[146:147], v[146:147], v[150:151]
    v_cvt_pk_bf16_f32 v152, v128, v129
    v_cvt_pk_bf16_f32 v153, v134, v135
    v_cvt_pk_bf16_f32 v154, v140, v141
    v_cvt_pk_bf16_f32 v155, v146, v147
    buffer_store_dwordx4 v[152:155], v27, s[32:35], s68 offen offset:2048 sc1
    v_pk_mul_f32 v[128:129], v[104:105], v[16:17] op_sel_hi:[1,0]
    v_pk_mul_f32 v[134:135], v[106:107], v[16:17] op_sel_hi:[1,0]
    v_pk_mul_f32 v[140:141], v[108:109], v[16:17] op_sel_hi:[1,0]
    v_pk_mul_f32 v[146:147], v[110:111], v[16:17] op_sel_hi:[1,0]
    v_pk_mul_f32 v[130:131], v[128:129], v[128:129]
    v_pk_mul_f32 v[136:137], v[134:135], v[134:135]
    v_pk_mul_f32 v[142:143], v[140:141], v[140:141]
    v_pk_mul_f32 v[148:149], v[146:147], v[146:147]
    v_pk_fma_f32 v[130:131], v[130:131], v[20:21], s[66:67]
    v_pk_fma_f32 v[136:137], v[136:137], v[20:21], s[66:67]
    v_pk_fma_f32 v[142:143], v[142:143], v[20:21], s[66:67]
    v_pk_fma_f32 v[148:149], v[148:149], v[20:21], s[66:67]
    v_pk_mul_f32 v[132:133], v[128:129], v[130:131]
    v_pk_mul_f32 v[138:139], v[134:135], v[136:137]
    v_pk_mul_f32 v[144:145], v[140:141], v[142:143]
    v_pk_mul_f32 v[150:151], v[146:147], v[148:149]
    v_exp_f32 v132, v132
    v_exp_f32 v133, v133
    v_exp_f32 v138, v138
    v_exp_f32 v139, v139
    v_exp_f32 v144, v144
    v_exp_f32 v145, v145
    v_exp_f32 v150, v150
    v_exp_f32 v151, v151
    v_pk_add_f32 v[132:133], v[132:133], v[22:23]
    v_pk_add_f32 v[138:139], v[138:139], v[22:23]
    v_pk_add_f32 v[144:145], v[144:145], v[22:23]
    v_pk_add_f32 v[150:151], v[150:151], v[22:23]
    v_rcp_f32 v132, v132
    v_rcp_f32 v133, v133
    v_rcp_f32 v138, v138
    v_rcp_f32 v139, v139
    v_rcp_f32 v144, v144
    v_rcp_f32 v145, v145
    v_rcp_f32 v150, v150
    v_rcp_f32 v151, v151
    v_pk_mul_f32 v[128:129], v[128:129], v[132:133]
    v_pk_mul_f32 v[134:135], v[134:135], v[138:139]
    v_pk_mul_f32 v[140:141], v[140:141], v[144:145]
    v_pk_mul_f32 v[146:147], v[146:147], v[150:151]
    v_cvt_pk_bf16_f32 v156, v128, v129
    v_cvt_pk_bf16_f32 v157, v134, v135
    v_cvt_pk_bf16_f32 v158, v140, v141
    v_cvt_pk_bf16_f32 v159, v146, v147
    buffer_store_dwordx4 v[156:159], v27, s[32:35], s68 offen offset:3072 sc1
    v_pk_mul_f32 v[128:129], v[112:113], v[18:19] op_sel_hi:[1,0]
    v_pk_mul_f32 v[134:135], v[114:115], v[18:19] op_sel_hi:[1,0]
    v_pk_mul_f32 v[140:141], v[116:117], v[18:19] op_sel_hi:[1,0]
    v_pk_mul_f32 v[146:147], v[118:119], v[18:19] op_sel_hi:[1,0]
    v_pk_mul_f32 v[130:131], v[128:129], v[128:129]
    v_pk_mul_f32 v[136:137], v[134:135], v[134:135]
    v_pk_mul_f32 v[142:143], v[140:141], v[140:141]
    v_pk_mul_f32 v[148:149], v[146:147], v[146:147]
    v_pk_fma_f32 v[130:131], v[130:131], v[20:21], s[66:67]
    v_pk_fma_f32 v[136:137], v[136:137], v[20:21], s[66:67]
    v_pk_fma_f32 v[142:143], v[142:143], v[20:21], s[66:67]
    v_pk_fma_f32 v[148:149], v[148:149], v[20:21], s[66:67]
    v_pk_mul_f32 v[132:133], v[128:129], v[130:131]
    v_pk_mul_f32 v[138:139], v[134:135], v[136:137]
    v_pk_mul_f32 v[144:145], v[140:141], v[142:143]
    v_pk_mul_f32 v[150:151], v[146:147], v[148:149]
    v_exp_f32 v132, v132
    v_exp_f32 v133, v133
    v_exp_f32 v138, v138
    v_exp_f32 v139, v139
    v_exp_f32 v144, v144
    v_exp_f32 v145, v145
    v_exp_f32 v150, v150
    v_exp_f32 v151, v151
    v_pk_add_f32 v[132:133], v[132:133], v[22:23]
    v_pk_add_f32 v[138:139], v[138:139], v[22:23]
    v_pk_add_f32 v[144:145], v[144:145], v[22:23]
    v_pk_add_f32 v[150:151], v[150:151], v[22:23]
    v_rcp_f32 v132, v132
    v_rcp_f32 v133, v133
    v_rcp_f32 v138, v138
    v_rcp_f32 v139, v139
    v_rcp_f32 v144, v144
    v_rcp_f32 v145, v145
    v_rcp_f32 v150, v150
    v_rcp_f32 v151, v151
    v_pk_mul_f32 v[128:129], v[128:129], v[132:133]
    v_pk_mul_f32 v[134:135], v[134:135], v[138:139]
    v_pk_mul_f32 v[140:141], v[140:141], v[144:145]
    v_pk_mul_f32 v[146:147], v[146:147], v[150:151]
    v_cvt_pk_bf16_f32 v160, v128, v129
    v_cvt_pk_bf16_f32 v161, v134, v135
    v_cvt_pk_bf16_f32 v162, v140, v141
    v_cvt_pk_bf16_f32 v163, v146, v147
    buffer_store_dwordx4 v[160:163], v27, s[32:35], s69 offen offset:2048 sc1
    v_pk_mul_f32 v[128:129], v[120:121], v[18:19] op_sel_hi:[1,0]
    v_pk_mul_f32 v[134:135], v[122:123], v[18:19] op_sel_hi:[1,0]
    v_pk_mul_f32 v[140:141], v[124:125], v[18:19] op_sel_hi:[1,0]
    v_pk_mul_f32 v[146:147], v[126:127], v[18:19] op_sel_hi:[1,0]
    v_pk_mul_f32 v[130:131], v[128:129], v[128:129]
    v_pk_mul_f32 v[136:137], v[134:135], v[134:135]
    v_pk_mul_f32 v[142:143], v[140:141], v[140:141]
    v_pk_mul_f32 v[148:149], v[146:147], v[146:147]
    v_pk_fma_f32 v[130:131], v[130:131], v[20:21], s[66:67]
    v_pk_fma_f32 v[136:137], v[136:137], v[20:21], s[66:67]
    v_pk_fma_f32 v[142:143], v[142:143], v[20:21], s[66:67]
    v_pk_fma_f32 v[148:149], v[148:149], v[20:21], s[66:67]
    v_pk_mul_f32 v[132:133], v[128:129], v[130:131]
    v_pk_mul_f32 v[138:139], v[134:135], v[136:137]
    v_pk_mul_f32 v[144:145], v[140:141], v[142:143]
    v_pk_mul_f32 v[150:151], v[146:147], v[148:149]
    v_exp_f32 v132, v132
    v_exp_f32 v133, v133
    v_exp_f32 v138, v138
    v_exp_f32 v139, v139
    v_exp_f32 v144, v144
    v_exp_f32 v145, v145
    v_exp_f32 v150, v150
    v_exp_f32 v151, v151
    v_pk_add_f32 v[132:133], v[132:133], v[22:23]
    v_pk_add_f32 v[138:139], v[138:139], v[22:23]
    v_pk_add_f32 v[144:145], v[144:145], v[22:23]
    v_pk_add_f32 v[150:151], v[150:151], v[22:23]
    v_rcp_f32 v132, v132
    v_rcp_f32 v133, v133
    v_rcp_f32 v138, v138
    v_rcp_f32 v139, v139
    v_rcp_f32 v144, v144
    v_rcp_f32 v145, v145
    v_rcp_f32 v150, v150
    v_rcp_f32 v151, v151
    v_pk_mul_f32 v[128:129], v[128:129], v[132:133]
    v_pk_mul_f32 v[134:135], v[134:135], v[138:139]
    v_pk_mul_f32 v[140:141], v[140:141], v[144:145]
    v_pk_mul_f32 v[146:147], v[146:147], v[150:151]
    v_cvt_pk_bf16_f32 v164, v128, v129
    v_cvt_pk_bf16_f32 v165, v134, v135
    v_cvt_pk_bf16_f32 v166, v140, v141
    v_cvt_pk_bf16_f32 v167, v146, v147
    buffer_store_dwordx4 v[164:167], v27, s[32:35], s69 offen offset:3072 sc1
    s_waitcnt vmcnt(0)
    v_mov_b32 v20, s27
    v_mov_b32 v21, 0
    s_mov_b64 exec, 1
    buffer_store_dword v20, v21, s[48:51], s70 offen sc1
    s_mov_b64 exec, -1
    s_branch Lc2
Lwj_c:
    s_waitcnt lgkmcnt(0)
    s_barrier
    s_branch Lwj
Lwj_l:
    s_add_u32 s26, s26, 4
    s_waitcnt lgkmcnt(0)
    s_barrier
Lwj:
    s_and_b32 s64, s26, 1
    s_lshr_b32 s65, s26, 1
    s_cmp_eq_u32 s64, 0
    s_cselect_b32 s52, s6, s8
    s_cselect_b32 s53, s7, s9
    s_mov_b32 s54, 1314816
    s_mov_b32 s55, 0x00020000
    s_sub_u32 s66, s61, 28
    s_lshl_b32 s69, s60, 8
    s_lshl_b32 s58, s66, 4
    s_add_u32 s69, s69, s58
    s_lshl_b32 s58, s65, 6
    s_add_u32 s69, s69, s58
    v_lshlrev_b32 v11, 4, v0
    s_add_u32 s58, s69, 2047
    s_and_b32 s58, s58, 2047
    s_mul_i32 s58, s58, 642
    s_sub_u32 s58, s58, 14
    s_mul_i32 s67, s26, 10944
    s_mov_b32 m0, s67
    s_mov_b32 exec_hi, 0x1ff
    buffer_load_dwordx4 v11, s[52:55], s58 offen lds
    s_mov_b64 exec, -1
    s_mul_i32 s58, s69, 642
    s_add_u32 m0, s67, 656
    s_nop 0
    buffer_load_dwordx4 v11, s[52:55], s58 offen offset:0 lds
    buffer_load_dwordx4 v11, s[52:55], s58 offen offset:1024 lds
    buffer_load_dwordx4 v11, s[52:55], s58 offen offset:2048 lds
    buffer_load_dwordx4 v11, s[52:55], s58 offen offset:3072 lds
    s_add_u32 s58, s58, 4096
    s_add_u32 m0, s67, 4752
    s_nop 0
    buffer_load_dwordx4 v11, s[52:55], s58 offen offset:0 lds
    buffer_load_dwordx4 v11, s[52:55], s58 offen offset:1024 lds
    buffer_load_dwordx4 v11, s[52:55], s58 offen offset:2048 lds
    buffer_load_dwordx4 v11, s[52:55], s58 offen offset:3072 lds
    s_add_u32 s58, s58, 4096
    s_add_u32 m0, s67, 8848
    s_nop 0
    buffer_load_dwordx4 v11, s[52:55], s58 offen offset:0 lds
    buffer_load_dwordx4 v11, s[52:55], s58 offen offset:1024 lds
    s_mov_b64 exec, 3
    buffer_load_dwordx4 v11, s[52:55], s58 offen offset:2048 lds
    s_mov_b64 exec, -1
    s_mov_b32 s48, s24
    s_mov_b32 s49, s25
    s_mov_b32 s50, 16777216
    s_mov_b32 s51, 0x00020000
    s_mov_b32 s40, s22
    s_mov_b32 s41, s23
    s_mov_b32 s42, 256
    s_mov_b32 s43, 0x00020000
    v_lshrrev_b32 v16, 3, v0
    v_and_b32 v19, 3, v0
    v_lshl_add_u32 v16, v16, 2, v19
    v_subrev_u32 v17, 20, v16
    v_min_u32 v17, v16, v17
    v_bfe_u32 v18, v0, 2, 1
    v_mul_u32_u24 v18, 1284, v18
    v_lshl_add_u32 v18, v16, 1, v18
    s_lshl_b32 s58, s65, 2
    s_add_u32 s58, s58, s64
    s_mul_i32 s58, s58, 642
    s_add_u32 s58, s58, 656
    v_add_u32 v20, s58, v18
    s_mul_i32 s58, s64, 1284
    v_subrev_u32 v21, s58, v20
    s_lshl_b32 s75, s60, 4
    s_lshl_b32 s58, s66, 2
    s_add_u32 s75, s75, s58
    s_add_u32 s75, s75, s65
    s_mul_i32 s75, s75, 20736
    s_mul_i32 s58, s64, 10368
    s_add_u32 s75, s75, s58
    s_add_u32 s75, s75, 4194304
    s_waitcnt vmcnt(0)
    v_mov_b32 v13, 0
    buffer_load_dword v12, v13, s[40:43], 0 offen sc1
    s_lshl_b32 s58, s26, 2
    s_add_u32 s58, s58, 157360
    v_mov_b32 v24, s58
    v_mov_b32 v25, 1
    ds_write_b32 v24, v25
    v_mov_b32 v28, 157360
    s_mov_b32 s30, 0
Lfw_2:
    ds_read_b128 v[24:27], v28
    s_waitcnt lgkmcnt(0)
    v_and_b32 v24, v24, v25
    v_and_b32 v26, v26, v27
    v_and_b32 v24, v24, v26
    s_nop 0
    v_readfirstlane_b32 s58, v24
    s_add_u32 s30, s30, 1
    s_cmp_ge_u32 s30, 320000
    s_cselect_b32 s58, 1, s58
    s_cmp_eq_u32 s58, 0
    s_cbranch_scc1 Lfw_2
    v_mov_b32 v28, 157376
    s_mov_b32 s30, 0
Lfw_3:
    ds_read_b128 v[24:27], v28
    s_waitcnt lgkmcnt(0)
    v_and_b32 v24, v24, v25
    v_and_b32 v26, v26, v27
    v_and_b32 v24, v24, v26
    s_nop 0
    v_readfirstlane_b32 s58, v24
    s_add_u32 s30, s30, 1
    s_cmp_ge_u32 s30, 320000
    s_cselect_b32 s58, 1, s58
    s_cmp_eq_u32 s58, 0
    s_cbranch_scc1 Lfw_3
    v_cmp_lt_u32 vcc, 10, v17
    s_nop 1
    v_cndmask_b32 v22, v20, v21, vcc
    v_add_u32 v17, 12, v17
    v_subrev_u32 v24, 20, v17
    v_min_u32 v17, v17, v24
    v_add_u32 v23, 65664, v22
    ds_read_u16 v32, v22 offset:0
    ds_read_u16_d16_hi v36, v22 offset:10944
    ds_read_u16 v33, v22 offset:21888
    ds_read_u16_d16_hi v37, v22 offset:32832
    ds_read_u16 v34, v22 offset:43776
    ds_read_u16_d16_hi v38, v22 offset:54720
    ds_read_u16 v35, v23 offset:0
    ds_read_u16_d16_hi v39, v23 offset:10944
    v_cmp_lt_u32 vcc, 10, v17
    s_nop 1
    v_cndmask_b32 v22, v20, v21, vcc
    v_add_u32 v17, 12, v17
    v_subrev_u32 v24, 20, v17
    v_min_u32 v17, v17, v24
    v_add_u32 v23, 65664, v22
    ds_read_u16 v48, v22 offset:64
    ds_read_u16_d16_hi v52, v22 offset:11008
    ds_read_u16 v49, v22 offset:21952
    ds_read_u16_d16_hi v53, v22 offset:32896
    ds_read_u16 v50, v22 offset:43840
    ds_read_u16_d16_hi v54, v22 offset:54784
    ds_read_u16 v51, v23 offset:64
    ds_read_u16_d16_hi v55, v23 offset:11008
    s_waitcnt lgkmcnt(8)
    v_or_b32 v40, v32, v36
    v_or_b32 v41, v33, v37
    v_or_b32 v42, v34, v38
    v_or_b32 v43, v35, v39
    buffer_store_dwordx4 v[40:43], v11, s[48:51], s75 offen offset:0 sc1
    v_cmp_lt_u32 vcc, 10, v17
    s_nop 1
    v_cndmask_b32 v22, v20, v21, vcc
    v_add_u32 v17, 12, v17
    v_subrev_u32 v24, 20, v17
    v_min_u32 v17, v17, v24
    v_add_u32 v23, 65664, v22
    ds_read_u16 v64, v22 offset:128
    ds_read_u16_d16_hi v68, v22 offset:11072
    ds_read_u16 v65, v22 offset:22016
    ds_read_u16_d16_hi v69, v22 offset:32960
    ds_read_u16 v66, v22 offset:43904
    ds_read_u16_d16_hi v70, v22 offset:54848
    ds_read_u16 v67, v23 offset:128
    ds_read_u16_d16_hi v71, v23 offset:11072
    s_waitcnt lgkmcnt(8)
    v_or_b32 v56, v48, v52
    v_or_b32 v57, v49, v53
    v_or_b32 v58, v50, v54
    v_or_b32 v59, v51, v55
    buffer_store_dwordx4 v[56:59], v11, s[48:51], s75 offen offset:1024 sc1
    v_cmp_lt_u32 vcc, 10, v17
    s_nop 1
    v_cndmask_b32 v22, v20, v21, vcc
    v_add_u32 v17, 12, v17
    v_subrev_u32 v24, 20, v17
    v_min_u32 v17, v17, v24
    v_add_u32 v23, 65664, v22
    ds_read_u16 v32, v22 offset:192
    ds_read_u16_d16_hi v36, v22 offset:11136
    ds_read_u16 v33, v22 offset:22080
    ds_read_u16_d16_hi v37, v22 offset:33024
    ds_read_u16 v34, v22 offset:43968
    ds_read_u16_d16_hi v38, v22 offset:54912
    ds_read_u16 v35, v23 offset:192
    ds_read_u16_d16_hi v39, v23 offset:11136
    s_waitcnt lgkmcnt(8)
    v_or_b32 v72, v64, v68
    v_or_b32 v73, v65, v69
    v_or_b32 v74, v66, v70
    v_or_b32 v75, v67, v71
    buffer_store_dwordx4 v[72:75], v11, s[48:51], s75 offen offset:2048 sc1
    v_cmp_lt_u32 vcc, 10, v17
    s_nop 1
    v_cndmask_b32 v22, v20, v21, vcc
    v_add_u32 v17, 12, v17
    v_subrev_u32 v24, 20, v17
    v_min_u32 v17, v17, v24
    v_add_u32 v23, 65664, v22
    ds_read_u16 v48, v22 offset:256
    ds_read_u16_d16_hi v52, v22 offset:11200
    ds_read_u16 v49, v22 offset:22144
    ds_read_u16_d16_hi v53, v22 offset:33088
    ds_read_u16 v50, v22 offset:44032
    ds_read_u16_d16_hi v54, v22 offset:54976
    ds_read_u16 v51, v23 offset:256
    ds_read_u16_d16_hi v55, v23 offset:11200
    s_waitcnt lgkmcnt(8)
    v_or_b32 v40, v32, v36
    v_or_b32 v41, v33, v37
    v_or_b32 v42, v34, v38
    v_or_b32 v43, v35, v39
    buffer_store_dwordx4 v[40:43], v11, s[48:51], s75 offen offset:3072 sc1
    s_add_u32 s75, s75, 4096
    v_cmp_lt_u32 vcc, 10, v17
    s_nop 1
    v_cndmask_b32 v22, v20, v21, vcc
    v_add_u32 v17, 12, v17
    v_subrev_u32 v24, 20, v17
    v_min_u32 v17, v17, v24
    v_add_u32 v23, 65664, v22
    ds_read_u16 v64, v22 offset:320
    ds_read_u16_d16_hi v68, v22 offset:11264
    ds_read_u16 v65, v22 offset:22208
    ds_read_u16_d16_hi v69, v22 offset:33152
    ds_read_u16 v66, v22 offset:44096
    ds_read_u16_d16_hi v70, v22 offset:55040
    ds_read_u16 v67, v23 offset:320
    ds_read_u16_d16_hi v71, v23 offset:11264
    s_waitcnt lgkmcnt(8)
    v_or_b32 v56, v48, v52
    v_or_b32 v57, v49, v53
    v_or_b32 v58, v50, v54
    v_or_b32 v59, v51, v55
    buffer_store_dwordx4 v[56:59], v11, s[48:51], s75 offen offset:0 sc1
    v_cmp_lt_u32 vcc, 10, v17
    s_nop 1
    v_cndmask_b32 v22, v20, v21, vcc
    v_add_u32 v17, 12, v17
    v_subrev_u32 v24, 20, v17
    v_min_u32 v17, v17, v24
    v_add_u32 v23, 65664, v22
    ds_read_u16 v32, v22 offset:384
    ds_read_u16_d16_hi v36, v22 offset:11328
    ds_read_u16 v33, v22 offset:22272
    ds_read_u16_d16_hi v37, v22 offset:33216
    ds_read_u16 v34, v22 offset:44160
    ds_read_u16_d16_hi v38, v22 offset:55104
    ds_read_u16 v35, v23 offset:384
    ds_read_u16_d16_hi v39, v23 offset:11328
    s_waitcnt lgkmcnt(8)
    v_or_b32 v72, v64, v68
    v_or_b32 v73, v65, v69
    v_or_b32 v74, v66, v70
    v_or_b32 v75, v67, v71
    buffer_store_dwordx4 v[72:75], v11, s[48:51], s75 offen offset:1024 sc1
    v_cmp_lt_u32 vcc, 10, v17
    s_nop 1
    v_cndmask_b32 v22, v20, v21, vcc
    v_add_u32 v17, 12, v17
    v_subrev_u32 v24, 20, v17
    v_min_u32 v17, v17, v24
    v_add_u32 v23, 65664, v22
    ds_read_u16 v48, v22 offset:448
    ds_read_u16_d16_hi v52, v22 offset:11392
    ds_read_u16 v49, v22 offset:22336
    ds_read_u16_d16_hi v53, v22 offset:33280
    ds_read_u16 v50, v22 offset:44224
    ds_read_u16_d16_hi v54, v22 offset:55168
    ds_read_u16 v51, v23 offset:448
    ds_read_u16_d16_hi v55, v23 offset:11392
    s_waitcnt lgkmcnt(8)
    v_or_b32 v40, v32, v36
    v_or_b32 v41, v33, v37
    v_or_b32 v42, v34, v38
    v_or_b32 v43, v35, v39
    buffer_store_dwordx4 v[40:43], v11, s[48:51], s75 offen offset:2048 sc1
    v_cmp_lt_u32 vcc, 10, v17
    s_nop 1
    v_cndmask_b32 v22, v20, v21, vcc
    v_add_u32 v17, 12, v17
    v_subrev_u32 v24, 20, v17
    v_min_u32 v17, v17, v24
    v_add_u32 v23, 65664, v22
    ds_read_u16 v64, v22 offset:512
    ds_read_u16_d16_hi v68, v22 offset:11456
    ds_read_u16 v65, v22 offset:22400
    ds_read_u16_d16_hi v69, v22 offset:33344
    ds_read_u16 v66, v22 offset:44288
    ds_read_u16_d16_hi v70, v22 offset:55232
    ds_read_u16 v67, v23 offset:512
    ds_read_u16_d16_hi v71, v23 offset:11456
    s_waitcnt lgkmcnt(8)
    v_or_b32 v56, v48, v52
    v_or_b32 v57, v49, v53
    v_or_b32 v58, v50, v54
    v_or_b32 v59, v51, v55
    buffer_store_dwordx4 v[56:59], v11, s[48:51], s75 offen offset:3072 sc1
    s_add_u32 s75, s75, 4096
    v_cmp_lt_u32 vcc, 10, v17
    s_nop 1
    v_cndmask_b32 v22, v20, v21, vcc
    v_add_u32 v17, 12, v17
    v_subrev_u32 v24, 20, v17
    v_min_u32 v17, v17, v24
    v_add_u32 v23, 65664, v22
    ds_read_u16 v32, v22 offset:576
    ds_read_u16_d16_hi v36, v22 offset:11520
    ds_read_u16 v33, v22 offset:22464
    ds_read_u16_d16_hi v37, v22 offset:33408
    ds_read_u16 v34, v22 offset:44352
    ds_read_u16_d16_hi v38, v22 offset:55296
    ds_read_u16 v35, v23 offset:576
    ds_read_u16_d16_hi v39, v23 offset:11520
    s_waitcnt lgkmcnt(8)
    v_or_b32 v72, v64, v68
    v_or_b32 v73, v65, v69
    v_or_b32 v74, v66, v70
    v_or_b32 v75, v67, v71
    buffer_store_dwordx4 v[72:75], v11, s[48:51], s75 offen offset:0 sc1
    v_mov_b32 v22, v21
    v_add_u32 v23, 65664, v22
    ds_read_u16 v48, v22 offset:640
    ds_read_u16_d16_hi v52, v22 offset:11584
    ds_read_u16 v49, v22 offset:22528
    ds_read_u16_d16_hi v53, v22 offset:33472
    ds_read_u16 v50, v22 offset:44416
    ds_read_u16_d16_hi v54, v22 offset:55360
    ds_read_u16 v51, v23 offset:640
    ds_read_u16_d16_hi v55, v23 offset:11584
    s_waitcnt lgkmcnt(8)
    v_or_b32 v40, v32, v36
    v_or_b32 v41, v33, v37
    v_or_b32 v42, v34, v38
    v_or_b32 v43, v35, v39
    buffer_store_dwordx4 v[40:43], v11, s[48:51], s75 offen offset:1024 sc1
    s_waitcnt lgkmcnt(0)
    v_or_b32 v56, v48, v52
    v_or_b32 v57, v49, v53
    v_or_b32 v58, v50, v54
    v_or_b32 v59, v51, v55
    s_mov_b64 exec, 0xff
    buffer_store_dwordx4 v[56:59], v11, s[48:51], s75 offen offset:2048 sc1
    s_mov_b64 exec, -1
    s_waitcnt vmcnt(11)
    v_readfirstlane_b32 s27, v12
    s_nop 0
    s_cmp_lg_u32 s27, 0
    s_cbranch_scc1 Lnok_4
    s_mov_b32 s30, 0
Lnlp_5:
    s_add_u32 s30, s30, 1
    s_cmp_lg_u32 s30, 200
    s_cbranch_scc1 Lnsk_6
    s_memrealtime s[58:59]
    s_waitcnt lgkmcnt(0)
    s_or_b32 s31, s58, 1
    v_mov_b32 v14, s31
    v_mov_b32 v15, 0
    buffer_atomic_cmpswap v[14:15], v13, s[40:43], 0 offen sc1
Lnsk_6:
    buffer_load_dword v12, v13, s[40:43], 0 offen sc1
    s_waitcnt vmcnt(0)
    v_readfirstlane_b32 s27, v12
    s_nop 0
    s_cmp_lg_u32 s27, 0
    s_cbranch_scc1 Lnok_4
    s_cmp_lt_u32 s30, 40000
    s_cbranch_scc1 Lnlp_5
Lnok_4:
    s_waitcnt vmcnt(0)
    s_lshl_b32 s58, s26, 2
    s_add_u32 s58, s58, 157392
    v_mov_b32 v24, s58
    v_mov_b32 v25, 1
    ds_write_b32 v24, v25
    v_mov_b32 v28, 157392
    s_mov_b32 s30, 0
Lfw_7:
    ds_read_b128 v[24:27], v28
    s_waitcnt lgkmcnt(0)
    v_and_b32 v24, v24, v25
    v_and_b32 v26, v26, v27
    v_and_b32 v24, v24, v26
    s_nop 0
    v_readfirstlane_b32 s58, v24
    s_add_u32 s30, s30, 1
    s_cmp_ge_u32 s30, 320000
    s_cselect_b32 s58, 1, s58
    s_cmp_eq_u32 s58, 0
    s_cbranch_scc1 Lfw_7
    v_mov_b32 v28, 157408
    s_mov_b32 s30, 0
Lfw_8:
    ds_read_b128 v[24:27], v28
    s_waitcnt lgkmcnt(0)
    v_and_b32 v24, v24, v25
    v_and_b32 v26, v26, v27
    v_and_b32 v24, v24, v26
    s_nop 0
    v_readfirstlane_b32 s58, v24
    s_add_u32 s30, s30, 1
    s_cmp_ge_u32 s30, 320000
    s_cselect_b32 s58, 1, s58
    s_cmp_eq_u32 s58, 0
    s_cbranch_scc1 Lfw_8
    s_cmp_lg_u32 s26, 0
    s_cbranch_scc1 Lwnf
    s_lshl_b32 s58, s60, 2
    s_add_u32 s58, s58, s66
    s_lshl_b32 s58, s58, 4
    s_add_u32 s59, s58, 724992
    v_mov_b32 v18, s27
    v_mov_b32 v19, 0
    s_mov_b64 exec, 1
    buffer_store_dword v18, v19, s[48:51], s59 offen sc1
    s_mov_b64 exec, -1
Lwnf:
    s_cmp_ge_u32 s26, 4
    s_cbranch_scc1 Lwj_e
    s_lshl_b32 s58, s26, 2
    s_add_u32 s58, s58, 157440
    v_mov_b32 v20, s58
    v_mov_b32 v21, 1
    ds_write_b32 v20, v21
    s_cmp_ge_u32 s26, 2
    s_cbranch_scc1 Lwj_c2
    s_mul_i32 s58, s60, 6
    s_add_u32 s59, s58, 5
    s_lshr_b32 s58, s58, 4
    s_lshr_b32 s59, s59, 4
    s_add_u32 s59, s59, 1
    s_mul_i32 s58, s58, 737280
    s_mul_i32 s59, s59, 737280
    s_mov_b32 s32, s16
    s_mov_b32 s33, s17
    s_mov_b32 s34, s59
    s_mov_b32 s35, 0x00020000
    v_lshlrev_b32 v18, 7, v0
    s_lshl_b32 s30, s61, 1
    s_add_u32 s30, s30, s26
    s_lshl_b32 s30, s30, 13
    s_add_u32 s58, s58, s30
    buffer_load_dword v1, v18, s[32:35], s58 offen
    s_add_u32 s58, s58, 524288
    buffer_load_dword v1, v18, s[32:35], s58 offen
    s_add_u32 s58, s58, 524288
    buffer_load_dword v1, v18, s[32:35], s58 offen
    s_add_u32 s58, s58, 524288
Lwj_c2:
    s_mov_b32 s48, s24
    s_mov_b32 s49, s25
    s_mov_b32 s50, 33554432
    s_mov_b32 s51, 0x00020000
    s_branch Lc2
Lwj_e:
    s_sub_u32 s26, s26, 4
    s_setprio 2
    v_lshlrev_b32 v24, 4, v0
    v_add_u32 v24, 120832, v24
    ds_read_b128 v[64:67], v24 offset:0
    ds_read_b128 v[68:71], v24 offset:1024
    ds_read_b128 v[72:75], v24 offset:2048
    ds_read_b128 v[76:79], v24 offset:3072
    ds_read_b128 v[80:83], v24 offset:4096
    ds_read_b128 v[84:87], v24 offset:5120
    ds_read_b128 v[88:91], v24 offset:6144
    ds_read_b128 v[92:95], v24 offset:7168
    v_lshrrev_b32 v20, 5, v0
    v_and_b32 v21, 31, v0
    v_cvt_f32_u32 v26, v20
    v_mul_f32 v26, 4.0, v26
    v_cvt_f32_u32 v27, v21
    v_mul_f32 v22, 0x3a800000, v27
    v_mul_f32 v24, v26, v22
    v_fmamk_f32 v112, v22, 0x00000000, v24
    v_fmamk_f32 v113, v22, 0x3f800000, v24
    v_fmamk_f32 v114, v22, 0x40000000, v24
    v_fmamk_f32 v115, v22, 0x40400000, v24
    v_fmamk_f32 v116, v22, 0x41000000, v24
    v_fmamk_f32 v117, v22, 0x41100000, v24
    v_fmamk_f32 v118, v22, 0x41200000, v24
    v_fmamk_f32 v119, v22, 0x41300000, v24
    v_fmamk_f32 v120, v22, 0x41800000, v24
    v_fmamk_f32 v121, v22, 0x41880000, v24
    v_fmamk_f32 v122, v22, 0x41900000, v24
    v_fmamk_f32 v123, v22, 0x41980000, v24
    v_fmamk_f32 v124, v22, 0x41c00000, v24
    v_fmamk_f32 v125, v22, 0x41c80000, v24
    v_fmamk_f32 v126, v22, 0x41d00000, v24
    v_fmamk_f32 v127, v22, 0x41d80000, v24
    v_cos_f32 v96, v112
    v_sin_f32 v112, v112
    v_cos_f32 v97, v113
    v_sin_f32 v113, v113
    v_cos_f32 v98, v114
    v_sin_f32 v114, v114
    v_cos_f32 v99, v115
    v_sin_f32 v115, v115
    v_cos_f32 v100, v116
    v_sin_f32 v116, v116
    v_cos_f32 v101, v117
    v_sin_f32 v117, v117
    v_cos_f32 v102, v118
    v_sin_f32 v118, v118
    v_cos_f32 v103, v119
    v_sin_f32 v119, v119
    v_cos_f32 v104, v120
    v_sin_f32 v120, v120
    v_cos_f32 v105, v121
    v_sin_f32 v121, v121
    v_cos_f32 v106, v122
    v_sin_f32 v122, v122
    v_cos_f32 v107, v123
    v_sin_f32 v123, v123
    v_cos_f32 v108, v124
    v_sin_f32 v124, v124
    v_cos_f32 v109, v125
    v_sin_f32 v125, v125
    v_cos_f32 v110, v126
    v_sin_f32 v126, v126
    v_cos_f32 v111, v127
    v_sin_f32 v127, v127
    v_cmp_lt_u32 vcc, 15, v21
    v_mov_b32 v22, 0x80008000
    s_nop 0
    v_cndmask_b32 v22, 0, v22, vcc
    s_waitcnt lgkmcnt(0)
    v_xor_b32 v80, v22, v80
    v_xor_b32 v81, v22, v81
    v_xor_b32 v82, v22, v82
    v_xor_b32 v83, v22, v83
    v_xor_b32 v84, v22, v84
    v_xor_b32 v85, v22, v85
    v_xor_b32 v86, v22, v86
    v_xor_b32 v87, v22, v87
    v_xor_b32 v88, v22, v88
    v_xor_b32 v89, v22, v89
    v_xor_b32 v90, v22, v90
    v_xor_b32 v91, v22, v91
    v_xor_b32 v92, v22, v92
    v_xor_b32 v93, v22, v93
    v_xor_b32 v94, v22, v94
    v_xor_b32 v95, v22, v95
    s_branch Ll2
Lc2:
    s_mul_i32 s65, s61, 52
    s_lshr_b32 s65, s65, 8
    s_mul_i32 s58, s65, 5
    s_sub_u32 s63, s61, s58
    s_mul_i32 s58, s60, 6
    s_add_u32 s58, s58, s65
    s_lshr_b32 s64, s58, 4
    s_and_b32 s62, s58, 15
    s_lshl_b32 s78, s60, 5
    s_add_u32 s78, s78, s61
    s_lshl_b32 s79, s78, 2
    s_add_u32 s79, s79, s26
    s_add_u32 s80, s79, 1024
    s_mul_i32 s80, s80, 1280
    s_mul_i32 s81, s26, 2880
    s_add_u32 s81, s81, 77056
    v_lshlrev_b32 v27, 4, v0
    s_mov_b32 s44, s4
    s_mov_b32 s45, s5
    s_mov_b32 s46, 2621440
    s_mov_b32 s47, 0x00020000
    buffer_load_dwordx4 v[160:163], v27, s[44:47], s80 offen
    s_mov_b64 exec, 0xffff
    buffer_load_dwordx4 v[164:167], v27, s[44:47], s80 offen offset:1024
    s_mov_b64 exec, -1
    s_cmp_ge_u32 s61, 30
    s_cbranch_scc1 Lc2ng
    s_lshr_b32 s56, s26, 1
    s_and_b32 s57, s26, 1
    v_lshrrev_b32 v20, 5, v0
    v_and_b32 v21, 31, v0
    v_lshlrev_b32 v22, 4, v0
    s_lshl_b32 s58, s56, 13
    v_add_u32 v2, s58, v22
    v_add_u32 v3, 1024, v2
    v_add_u32 v4, 2048, v2
    v_add_u32 v5, 3072, v2
    v_add_u32 v6, 0x10000, v2
    v_add_u32 v7, 0x10000, v3
    v_add_u32 v8, 0x10000, v4
    v_add_u32 v9, 0x10000, v5
    v_bfe_u32 v22, v0, 2, 2
    v_lshl_add_u32 v23, v20, 2, v22
    v_lshlrev_b32 v23, 8, v23
    v_bfe_u32 v24, v0, 4, 1
    v_lshl_add_u32 v23, v24, 5, v23
    v_and_b32 v24, 3, v0
    v_lshl_add_u32 v23, v24, 3, v23
    v_add_u32 v23, 16384, v23
    s_lshl_b32 s58, s57, 1
    s_add_u32 s59, s58, 0
    v_xor_b32 v24, s59, v22
    v_lshl_add_u32 v10, v24, 6, v23
    v_add_u32 v12, 0x10000, v10
    s_add_u32 s59, s58, 1
    v_xor_b32 v24, s59, v22
    v_lshl_add_u32 v11, v24, 6, v23
    v_add_u32 v13, 0x10000, v11
    s_cmp_eq_u32 s64, 0
    s_cselect_b32 s67, 1280, 0
    s_mov_b32 s40, s18
    s_mov_b32 s41, s19
    s_mov_b32 s42, s67
    s_mov_b32 s43, 0x00020000
    s_lshl_b32 s58, s63, 8
    s_lshl_b32 s59, s57, 7
    s_add_u32 s58, s58, s59
    v_lshlrev_b32 v21, 1, v21
    buffer_load_ushort v56, v21, s[40:43], s58 offen
    buffer_load_ushort v60, v21, s[40:43], s58 offen offset:64
    v_min_u32 v19, 17, v0
    v_lshlrev_b32 v19, 4, v19
    s_mul_i32 s66, s62, 28
    s_mul_i32 s59, s64, 9
    s_add_u32 s66, s66, s59
    s_lshl_b32 s66, s66, 5
    s_add_u32 s66, s66, 786432
    v_cmp_lt_u32 vcc, 25, v0
    s_nop 1
    v_cndmask_b32_e64 v24, 0, 1, vcc
    v_mul_u32_u24 v25, 26, v24
    v_sub_u32 v25, v0, v25
    s_mul_i32 s58, s63, 26
    v_add_u32 v20, s58, v25
    v_lshrrev_b32 v22, 5, v20
    v_mul_u32_u24 v22, 110592, v22
    v_and_b32 v23, 31, v20
    v_lshl_add_u32 v16, v23, 7, v22
    v_lshl_add_u32 v16, v24, 12, v16
    v_mov_b32 v22, 2146435072
    v_cmp_gt_u32 vcc, 0x80, v20
    s_nop 1
    v_cndmask_b32 v16, v22, v16, vcc
    s_cmp_eq_u32 s26, 3
    s_cselect_b32 s58, 26, 52
    v_cmp_gt_u32 vcc, s58, v0
    s_nop 1
    v_cndmask_b32 v16, v22, v16, vcc
    s_mul_i32 s67, s62, 432
    s_mul_i32 s58, s64, 36
    s_add_u32 s67, s67, s58
    s_lshl_b32 s58, s26, 3
    s_add_u32 s67, s67, s58
    s_add_u32 s67, s67, 8
    s_lshl_b32 s67, s67, 10
    s_add_u32 s36, s24, 10485760
    s_addc_u32 s37, s25, 0
    s_mov_b32 s38, 7077888
    s_mov_b32 s39, 0x00020000
    s_add_u32 s32, s24, 18874368
    s_addc_u32 s33, s25, 0
    s_mov_b32 s34, 7864320
    s_mov_b32 s35, 0x00020000
    s_lshl_b32 s58, s64, 6
    s_lshl_b32 s59, s62, 2
    s_add_u32 s58, s58, s59
    s_lshl_b32 s59, s56, 1
    s_add_u32 s58, s58, s59
    s_mul_i32 s58, s58, 40
    s_lshl_b32 s59, s63, 3
    s_add_u32 s58, s58, s59
    s_lshl_b32 s59, s57, 2
    s_add_u32 s58, s58, s59
    s_lshl_b32 s74, s58, 10
    s_add_u32 s75, s74, 40960
    s_lshl_b32 s58, s62, 1
    s_add_u32 s58, s58, s56
    s_lshl_b32 s58, s58, 5
    s_mul_i32 s59, s64, 10
    s_add_u32 s58, s58, s59
    s_lshl_b32 s59, s63, 1
    s_add_u32 s58, s58, s59
    s_add_u32 s58, s58, s57
    s_lshl_b32 s58, s58, 7
    s_add_u32 s76, s58, 589824
    v_mov_b32 v57, 0
    v_mov_b32 v49, 0
    v_mov_b32 v58, 0
    v_mov_b32 v50, 0
    v_mov_b32 v59, 0
    v_mov_b32 v51, 0
    v_mov_b32 v61, 0
    v_mov_b32 v53, 0
    v_mov_b32 v62, 0
    v_mov_b32 v54, 0
    v_mov_b32 v63, 0
    v_mov_b32 v55, 0
    v_cmp_gt_u32 vcc, 32, v0
    v_mov_b32 v20, 0x3f80
    s_nop 0
    v_cndmask_b32 v48, 0, v20, vcc
    v_mov_b32 v52, v48
    s_cmp_lg_u32 s26, 0
    s_cbranch_scc1 Lpo_9_w
    s_mov_b32 s30, 0
Lpo_9:
    buffer_load_dword v20, v19, s[48:51], s66 offen offset:0 sc1
    s_waitcnt vmcnt(0)
    v_xor_b32 v20, s27, v20
    v_cmp_eq_u32 vcc, 0, v20
    s_nop 0
    s_cmp_eq_u64 vcc, -1
    s_cbranch_scc1 Lpo_9_ok
    s_add_u32 s30, s30, 1
    s_cmp_ge_u32 s30, 40000
    s_cbranch_scc1 Lpo_9_ok
    s_sleep 4
    s_branch Lpo_9
Lpo_9_ok:
    v_mov_b32 v24, 157504
    v_mov_b32 v20, 1
    v_mov_b32 v21, 1
    v_mov_b32 v22, 1
    v_mov_b32 v23, 1
    ds_write_b128 v24, v[20:23]
Lpo_9_w:
    v_mov_b32 v24, 157504
    s_mov_b32 s30, 0
Lfw_10:
    ds_read_b128 v[20:23], v24
    s_waitcnt lgkmcnt(0)
    v_and_b32 v20, v20, v21
    v_and_b32 v22, v22, v23
    v_and_b32 v20, v20, v22
    s_nop 0
    v_readfirstlane_b32 s58, v20
    s_add_u32 s30, s30, 1
    s_cmp_ge_u32 s30, 320000
    s_cselect_b32 s58, 1, s58
    s_cmp_eq_u32 s58, 0
    s_cbranch_scc1 Lfw_10
    s_setprio 0
    buffer_load_dword v14, v16, s[36:39], s67 offen sc1
    s_waitcnt vmcnt(1)
    v_mfma_f32_32x32x16_bf16 v[64:79], v[56:59], v[48:51], 0
    v_mfma_f32_32x32x16_bf16 v[80:95], v[56:59], v[52:55], 0
    v_mfma_f32_32x32x16_bf16 v[96:111], v[60:63], v[48:51], 0
    v_mfma_f32_32x32x16_bf16 v[112:127], v[60:63], v[52:55], 0
    s_barrier
    ds_read_b128 v[32:35], v2 offset:0
    ds_read_b128 v[36:39], v2 offset:4096
    ds_read_b64_tr_b16 v[40:41], v10 offset:0
    ds_read_b64_tr_b16 v[42:43], v10 offset:2048
    ds_read_b64_tr_b16 v[44:45], v11 offset:0
    ds_read_b64_tr_b16 v[46:47], v11 offset:2048
    s_waitcnt lgkmcnt(0)
    v_mfma_f32_32x32x16_bf16 v[64:79], v[40:43], v[32:35], v[64:79]
    ds_read_b128 v[48:51], v3 offset:0
    ds_read_b128 v[52:55], v3 offset:4096
    ds_read_b64_tr_b16 v[56:57], v10 offset:4096
    v_mfma_f32_32x32x16_bf16 v[80:95], v[40:43], v[36:39], v[80:95]
    ds_read_b64_tr_b16 v[58:59], v10 offset:6144
    ds_read_b64_tr_b16 v[60:61], v11 offset:4096
    ds_read_b64_tr_b16 v[62:63], v11 offset:6144
    v_mfma_f32_32x32x16_bf16 v[96:111], v[44:47], v[32:35], v[96:111]
    v_mfma_f32_32x32x16_bf16 v[112:127], v[44:47], v[36:39], v[112:127]
    s_waitcnt lgkmcnt(0)
    v_mfma_f32_32x32x16_bf16 v[64:79], v[56:59], v[48:51], v[64:79]
    ds_read_b128 v[32:35], v4 offset:0
    ds_read_b128 v[36:39], v4 offset:4096
    ds_read_b64_tr_b16 v[40:41], v10 offset:8192
    v_mfma_f32_32x32x16_bf16 v[80:95], v[56:59], v[52:55], v[80:95]
    ds_read_b64_tr_b16 v[42:43], v10 offset:10240
    ds_read_b64_tr_b16 v[44:45], v11 offset:8192
    ds_read_b64_tr_b16 v[46:47], v11 offset:10240
    v_mfma_f32_32x32x16_bf16 v[96:111], v[60:63], v[48:51], v[96:111]
    v_mfma_f32_32x32x16_bf16 v[112:127], v[60:63], v[52:55], v[112:127]
    s_waitcnt lgkmcnt(0)
    v_mfma_f32_32x32x16_bf16 v[64:79], v[40:43], v[32:35], v[64:79]
    ds_read_b128 v[48:51], v5 offset:0
    ds_read_b128 v[52:55], v5 offset:4096
    ds_read_b64_tr_b16 v[56:57], v10 offset:12288
    v_mfma_f32_32x32x16_bf16 v[80:95], v[40:43], v[36:39], v[80:95]
    ds_read_b64_tr_b16 v[58:59], v10 offset:14336
    ds_read_b64_tr_b16 v[60:61], v11 offset:12288
    ds_read_b64_tr_b16 v[62:63], v11 offset:14336
    v_mfma_f32_32x32x16_bf16 v[96:111], v[44:47], v[32:35], v[96:111]
    v_mfma_f32_32x32x16_bf16 v[112:127], v[44:47], v[36:39], v[112:127]
    s_waitcnt lgkmcnt(0)
    s_barrier
    v_mfma_f32_32x32x16_bf16 v[64:79], v[56:59], v[48:51], v[64:79]
    ds_read_b128 v[32:35], v2 offset:32768
    ds_read_b128 v[36:39], v2 offset:36864
    ds_read_b64_tr_b16 v[40:41], v10 offset:32768
    v_mfma_f32_32x32x16_bf16 v[80:95], v[56:59], v[52:55], v[80:95]
    ds_read_b64_tr_b16 v[42:43], v10 offset:34816
    ds_read_b64_tr_b16 v[44:45], v11 offset:32768
    ds_read_b64_tr_b16 v[46:47], v11 offset:34816
    v_mfma_f32_32x32x16_bf16 v[96:111], v[60:63], v[48:51], v[96:111]
    v_mfma_f32_32x32x16_bf16 v[112:127], v[60:63], v[52:55], v[112:127]
    s_waitcnt lgkmcnt(0)
    v_mfma_f32_32x32x16_bf16 v[64:79], v[40:43], v[32:35], v[64:79]
    ds_read_b128 v[48:51], v3 offset:32768
    ds_read_b128 v[52:55], v3 offset:36864
    ds_read_b64_tr_b16 v[56:57], v10 offset:36864
    v_mfma_f32_32x32x16_bf16 v[80:95], v[40:43], v[36:39], v[80:95]
    ds_read_b64_tr_b16 v[58:59], v10 offset:38912
    ds_read_b64_tr_b16 v[60:61], v11 offset:36864
    ds_read_b64_tr_b16 v[62:63], v11 offset:38912
    v_mfma_f32_32x32x16_bf16 v[96:111], v[44:47], v[32:35], v[96:111]
    v_mfma_f32_32x32x16_bf16 v[112:127], v[44:47], v[36:39], v[112:127]
    s_waitcnt lgkmcnt(0)
    v_mfma_f32_32x32x16_bf16 v[64:79], v[56:59], v[48:51], v[64:79]
    ds_read_b128 v[32:35], v4 offset:32768
    ds_read_b128 v[36:39], v4 offset:36864
    ds_read_b64_tr_b16 v[40:41], v10 offset:40960
    v_mfma_f32_32x32x16_bf16 v[80:95], v[56:59], v[52:55], v[80:95]
    ds_read_b64_tr_b16 v[42:43], v10 offset:43008
    ds_read_b64_tr_b16 v[44:45], v11 offset:40960
    ds_read_b64_tr_b16 v[46:47], v11 offset:43008
    v_mfma_f32_32x32x16_bf16 v[96:111], v[60:63], v[48:51], v[96:111]
    v_mfma_f32_32x32x16_bf16 v[112:127], v[60:63], v[52:55], v[112:127]
    s_waitcnt lgkmcnt(0)
    v_mfma_f32_32x32x16_bf16 v[64:79], v[40:43], v[32:35], v[64:79]
    ds_read_b128 v[48:51], v5 offset:32768
    ds_read_b128 v[52:55], v5 offset:36864
    ds_read_b64_tr_b16 v[56:57], v10 offset:45056
    v_mfma_f32_32x32x16_bf16 v[80:95], v[40:43], v[36:39], v[80:95]
    ds_read_b64_tr_b16 v[58:59], v10 offset:47104
    ds_read_b64_tr_b16 v[60:61], v11 offset:45056
    ds_read_b64_tr_b16 v[62:63], v11 offset:47104
    v_mfma_f32_32x32x16_bf16 v[96:111], v[44:47], v[32:35], v[96:111]
    v_mfma_f32_32x32x16_bf16 v[112:127], v[44:47], v[36:39], v[112:127]
    s_waitcnt lgkmcnt(0)
    s_barrier
    v_mfma_f32_32x32x16_bf16 v[64:79], v[56:59], v[48:51], v[64:79]
    ds_read_b128 v[32:35], v6 offset:0
    ds_read_b128 v[36:39], v6 offset:4096
    ds_read_b64_tr_b16 v[40:41], v12 offset:0
    v_mfma_f32_32x32x16_bf16 v[80:95], v[56:59], v[52:55], v[80:95]
    ds_read_b64_tr_b16 v[42:43], v12 offset:2048
    ds_read_b64_tr_b16 v[44:45], v13 offset:0
    ds_read_b64_tr_b16 v[46:47], v13 offset:2048
    v_mfma_f32_32x32x16_bf16 v[96:111], v[60:63], v[48:51], v[96:111]
    v_mfma_f32_32x32x16_bf16 v[112:127], v[60:63], v[52:55], v[112:127]
    s_waitcnt lgkmcnt(0)
    v_mfma_f32_32x32x16_bf16 v[64:79], v[40:43], v[32:35], v[64:79]
    ds_read_b128 v[48:51], v7 offset:0
    ds_read_b128 v[52:55], v7 offset:4096
    ds_read_b64_tr_b16 v[56:57], v12 offset:4096
    v_mfma_f32_32x32x16_bf16 v[80:95], v[40:43], v[36:39], v[80:95]
    ds_read_b64_tr_b16 v[58:59], v12 offset:6144
    ds_read_b64_tr_b16 v[60:61], v13 offset:4096
    ds_read_b64_tr_b16 v[62:63], v13 offset:6144
    v_mfma_f32_32x32x16_bf16 v[96:111], v[44:47], v[32:35], v[96:111]
    v_mfma_f32_32x32x16_bf16 v[112:127], v[44:47], v[36:39], v[112:127]
    s_waitcnt lgkmcnt(0)
    v_mfma_f32_32x32x16_bf16 v[64:79], v[56:59], v[48:51], v[64:79]
    ds_read_b128 v[32:35], v8 offset:0
    ds_read_b128 v[36:39], v8 offset:4096
    ds_read_b64_tr_b16 v[40:41], v12 offset:8192
    v_mfma_f32_32x32x16_bf16 v[80:95], v[56:59], v[52:55], v[80:95]
    ds_read_b64_tr_b16 v[42:43], v12 offset:10240
    ds_read_b64_tr_b16 v[44:45], v13 offset:8192
    ds_read_b64_tr_b16 v[46:47], v13 offset:10240
    v_mfma_f32_32x32x16_bf16 v[96:111], v[60:63], v[48:51], v[96:111]
    v_mfma_f32_32x32x16_bf16 v[112:127], v[60:63], v[52:55], v[112:127]
    s_waitcnt lgkmcnt(0)
    v_mfma_f32_32x32x16_bf16 v[64:79], v[40:43], v[32:35], v[64:79]
    ds_read_b128 v[48:51], v9 offset:0
    ds_read_b128 v[52:55], v9 offset:4096
    ds_read_b64_tr_b16 v[56:57], v12 offset:12288
    v_mfma_f32_32x32x16_bf16 v[80:95], v[40:43], v[36:39], v[80:95]
    ds_read_b64_tr_b16 v[58:59], v12 offset:14336
    ds_read_b64_tr_b16 v[60:61], v13 offset:12288
    ds_read_b64_tr_b16 v[62:63], v13 offset:14336
    v_mfma_f32_32x32x16_bf16 v[96:111], v[44:47], v[32:35], v[96:111]
    v_mfma_f32_32x32x16_bf16 v[112:127], v[44:47], v[36:39], v[112:127]
    s_waitcnt lgkmcnt(0)
    s_barrier
    v_mfma_f32_32x32x16_bf16 v[64:79], v[56:59], v[48:51], v[64:79]
    ds_read_b128 v[32:35], v6 offset:32768
    ds_read_b128 v[36:39], v6 offset:36864
    ds_read_b64_tr_b16 v[40:41], v12 offset:32768
    v_mfma_f32_32x32x16_bf16 v[80:95], v[56:59], v[52:55], v[80:95]
    ds_read_b64_tr_b16 v[42:43], v12 offset:34816
    ds_read_b64_tr_b16 v[44:45], v13 offset:32768
    ds_read_b64_tr_b16 v[46:47], v13 offset:34816
    v_mfma_f32_32x32x16_bf16 v[96:111], v[60:63], v[48:51], v[96:111]
    v_mfma_f32_32x32x16_bf16 v[112:127], v[60:63], v[52:55], v[112:127]
    s_waitcnt lgkmcnt(0)
    v_mfma_f32_32x32x16_bf16 v[64:79], v[40:43], v[32:35], v[64:79]
    ds_read_b128 v[48:51], v7 offset:32768
    ds_read_b128 v[52:55], v7 offset:36864
    ds_read_b64_tr_b16 v[56:57], v12 offset:36864
    v_mfma_f32_32x32x16_bf16 v[80:95], v[40:43], v[36:39], v[80:95]
    ds_read_b64_tr_b16 v[58:59], v12 offset:38912
    ds_read_b64_tr_b16 v[60:61], v13 offset:36864
    ds_read_b64_tr_b16 v[62:63], v13 offset:38912
    v_mfma_f32_32x32x16_bf16 v[96:111], v[44:47], v[32:35], v[96:111]
    v_mfma_f32_32x32x16_bf16 v[112:127], v[44:47], v[36:39], v[112:127]
    s_waitcnt lgkmcnt(0)
    v_mfma_f32_32x32x16_bf16 v[64:79], v[56:59], v[48:51], v[64:79]
    ds_read_b128 v[32:35], v8 offset:32768
    ds_read_b128 v[36:39], v8 offset:36864
    ds_read_b64_tr_b16 v[40:41], v12 offset:40960
    v_mfma_f32_32x32x16_bf16 v[80:95], v[56:59], v[52:55], v[80:95]
    ds_read_b64_tr_b16 v[42:43], v12 offset:43008
    ds_read_b64_tr_b16 v[44:45], v13 offset:40960
    ds_read_b64_tr_b16 v[46:47], v13 offset:43008
    v_mfma_f32_32x32x16_bf16 v[96:111], v[60:63], v[48:51], v[96:111]
    v_mfma_f32_32x32x16_bf16 v[112:127], v[60:63], v[52:55], v[112:127]
    s_waitcnt lgkmcnt(0)
    v_mfma_f32_32x32x16_bf16 v[64:79], v[40:43], v[32:35], v[64:79]
    ds_read_b128 v[48:51], v9 offset:32768
    ds_read_b128 v[52:55], v9 offset:36864
    ds_read_b64_tr_b16 v[56:57], v12 offset:45056
    v_mfma_f32_32x32x16_bf16 v[80:95], v[40:43], v[36:39], v[80:95]
    ds_read_b64_tr_b16 v[58:59], v12 offset:47104
    ds_read_b64_tr_b16 v[60:61], v13 offset:45056
    ds_read_b64_tr_b16 v[62:63], v13 offset:47104
    v_mfma_f32_32x32x16_bf16 v[96:111], v[44:47], v[32:35], v[96:111]
    v_mfma_f32_32x32x16_bf16 v[112:127], v[44:47], v[36:39], v[112:127]
    s_waitcnt lgkmcnt(0)
    s_barrier
    v_mfma_f32_32x32x16_bf16 v[64:79], v[56:59], v[48:51], v[64:79]
    ds_read_b128 v[32:35], v2 offset:0
    ds_read_b128 v[36:39], v2 offset:4096
    ds_read_b64_tr_b16 v[40:41], v10 offset:0
    v_mfma_f32_32x32x16_bf16 v[80:95], v[56:59], v[52:55], v[80:95]
    ds_read_b64_tr_b16 v[42:43], v10 offset:2048
    ds_read_b64_tr_b16 v[44:45], v11 offset:0
    ds_read_b64_tr_b16 v[46:47], v11 offset:2048
    v_mfma_f32_32x32x16_bf16 v[96:111], v[60:63], v[48:51], v[96:111]
    v_mfma_f32_32x32x16_bf16 v[112:127], v[60:63], v[52:55], v[112:127]
    s_waitcnt lgkmcnt(0)
    v_mfma_f32_32x32x16_bf16 v[64:79], v[40:43], v[32:35], v[64:79]
    ds_read_b128 v[48:51], v3 offset:0
    ds_read_b128 v[52:55], v3 offset:4096
    ds_read_b64_tr_b16 v[56:57], v10 offset:4096
    v_mfma_f32_32x32x16_bf16 v[80:95], v[40:43], v[36:39], v[80:95]
    ds_read_b64_tr_b16 v[58:59], v10 offset:6144
    ds_read_b64_tr_b16 v[60:61], v11 offset:4096
    ds_read_b64_tr_b16 v[62:63], v11 offset:6144
    v_mfma_f32_32x32x16_bf16 v[96:111], v[44:47], v[32:35], v[96:111]
    v_mfma_f32_32x32x16_bf16 v[112:127], v[44:47], v[36:39], v[112:127]
    s_waitcnt lgkmcnt(0)
    v_mfma_f32_32x32x16_bf16 v[64:79], v[56:59], v[48:51], v[64:79]
    ds_read_b128 v[32:35], v4 offset:0
    ds_read_b128 v[36:39], v4 offset:4096
    ds_read_b64_tr_b16 v[40:41], v10 offset:8192
    v_mfma_f32_32x32x16_bf16 v[80:95], v[56:59], v[52:55], v[80:95]
    ds_read_b64_tr_b16 v[42:43], v10 offset:10240
    ds_read_b64_tr_b16 v[44:45], v11 offset:8192
    ds_read_b64_tr_b16 v[46:47], v11 offset:10240
    v_mfma_f32_32x32x16_bf16 v[96:111], v[60:63], v[48:51], v[96:111]
    v_mfma_f32_32x32x16_bf16 v[112:127], v[60:63], v[52:55], v[112:127]
    s_waitcnt lgkmcnt(0)
    v_mfma_f32_32x32x16_bf16 v[64:79], v[40:43], v[32:35], v[64:79]
    ds_read_b128 v[48:51], v5 offset:0
    ds_read_b128 v[52:55], v5 offset:4096
    ds_read_b64_tr_b16 v[56:57], v10 offset:12288
    v_mfma_f32_32x32x16_bf16 v[80:95], v[40:43], v[36:39], v[80:95]
    ds_read_b64_tr_b16 v[58:59], v10 offset:14336
    ds_read_b64_tr_b16 v[60:61], v11 offset:12288
    ds_read_b64_tr_b16 v[62:63], v11 offset:14336
    v_mfma_f32_32x32x16_bf16 v[96:111], v[44:47], v[32:35], v[96:111]
    v_mfma_f32_32x32x16_bf16 v[112:127], v[44:47], v[36:39], v[112:127]
    s_waitcnt lgkmcnt(0)
    s_barrier
    v_mfma_f32_32x32x16_bf16 v[64:79], v[56:59], v[48:51], v[64:79]
    ds_read_b128 v[32:35], v2 offset:32768
    ds_read_b128 v[36:39], v2 offset:36864
    ds_read_b64_tr_b16 v[40:41], v10 offset:32768
    v_mfma_f32_32x32x16_bf16 v[80:95], v[56:59], v[52:55], v[80:95]
    ds_read_b64_tr_b16 v[42:43], v10 offset:34816
    ds_read_b64_tr_b16 v[44:45], v11 offset:32768
    ds_read_b64_tr_b16 v[46:47], v11 offset:34816
    v_mfma_f32_32x32x16_bf16 v[96:111], v[60:63], v[48:51], v[96:111]
    v_mfma_f32_32x32x16_bf16 v[112:127], v[60:63], v[52:55], v[112:127]
    s_waitcnt lgkmcnt(0)
    v_mfma_f32_32x32x16_bf16 v[64:79], v[40:43], v[32:35], v[64:79]
    ds_read_b128 v[48:51], v3 offset:32768
    ds_read_b128 v[52:55], v3 offset:36864
    ds_read_b64_tr_b16 v[56:57], v10 offset:36864
    v_mfma_f32_32x32x16_bf16 v[80:95], v[40:43], v[36:39], v[80:95]
    ds_read_b64_tr_b16 v[58:59], v10 offset:38912
    ds_read_b64_tr_b16 v[60:61], v11 offset:36864
    ds_read_b64_tr_b16 v[62:63], v11 offset:38912
    v_mfma_f32_32x32x16_bf16 v[96:111], v[44:47], v[32:35], v[96:111]
    v_mfma_f32_32x32x16_bf16 v[112:127], v[44:47], v[36:39], v[112:127]
    s_waitcnt lgkmcnt(0)
    v_mfma_f32_32x32x16_bf16 v[64:79], v[56:59], v[48:51], v[64:79]
    ds_read_b128 v[32:35], v4 offset:32768
    ds_read_b128 v[36:39], v4 offset:36864
    ds_read_b64_tr_b16 v[40:41], v10 offset:40960
    v_mfma_f32_32x32x16_bf16 v[80:95], v[56:59], v[52:55], v[80:95]
    ds_read_b64_tr_b16 v[42:43], v10 offset:43008
    ds_read_b64_tr_b16 v[44:45], v11 offset:40960
    ds_read_b64_tr_b16 v[46:47], v11 offset:43008
    v_mfma_f32_32x32x16_bf16 v[96:111], v[60:63], v[48:51], v[96:111]
    v_mfma_f32_32x32x16_bf16 v[112:127], v[60:63], v[52:55], v[112:127]
    s_waitcnt lgkmcnt(0)
    v_mfma_f32_32x32x16_bf16 v[64:79], v[40:43], v[32:35], v[64:79]
    ds_read_b128 v[48:51], v5 offset:32768
    ds_read_b128 v[52:55], v5 offset:36864
    ds_read_b64_tr_b16 v[56:57], v10 offset:45056
    v_mfma_f32_32x32x16_bf16 v[80:95], v[40:43], v[36:39], v[80:95]
    ds_read_b64_tr_b16 v[58:59], v10 offset:47104
    ds_read_b64_tr_b16 v[60:61], v11 offset:45056
    ds_read_b64_tr_b16 v[62:63], v11 offset:47104
    v_mfma_f32_32x32x16_bf16 v[96:111], v[44:47], v[32:35], v[96:111]
    v_mfma_f32_32x32x16_bf16 v[112:127], v[44:47], v[36:39], v[112:127]
    s_waitcnt lgkmcnt(0)
    s_barrier
    v_mfma_f32_32x32x16_bf16 v[64:79], v[56:59], v[48:51], v[64:79]
    ds_read_b128 v[32:35], v6 offset:0
    ds_read_b128 v[36:39], v6 offset:4096
    ds_read_b64_tr_b16 v[40:41], v12 offset:0
    v_mfma_f32_32x32x16_bf16 v[80:95], v[56:59], v[52:55], v[80:95]
    ds_read_b64_tr_b16 v[42:43], v12 offset:2048
    ds_read_b64_tr_b16 v[44:45], v13 offset:0
    ds_read_b64_tr_b16 v[46:47], v13 offset:2048
    v_mfma_f32_32x32x16_bf16 v[96:111], v[60:63], v[48:51], v[96:111]
    v_mfma_f32_32x32x16_bf16 v[112:127], v[60:63], v[52:55], v[112:127]
    s_waitcnt lgkmcnt(0)
    v_mfma_f32_32x32x16_bf16 v[64:79], v[40:43], v[32:35], v[64:79]
    ds_read_b128 v[48:51], v7 offset:0
    ds_read_b128 v[52:55], v7 offset:4096
    ds_read_b64_tr_b16 v[56:57], v12 offset:4096
    v_mfma_f32_32x32x16_bf16 v[80:95], v[40:43], v[36:39], v[80:95]
    ds_read_b64_tr_b16 v[58:59], v12 offset:6144
    ds_read_b64_tr_b16 v[60:61], v13 offset:4096
    ds_read_b64_tr_b16 v[62:63], v13 offset:6144
    v_mfma_f32_32x32x16_bf16 v[96:111], v[44:47], v[32:35], v[96:111]
    v_mfma_f32_32x32x16_bf16 v[112:127], v[44:47], v[36:39], v[112:127]
    s_waitcnt lgkmcnt(0)
    v_mfma_f32_32x32x16_bf16 v[64:79], v[56:59], v[48:51], v[64:79]
    ds_read_b128 v[32:35], v8 offset:0
    ds_read_b128 v[36:39], v8 offset:4096
    ds_read_b64_tr_b16 v[40:41], v12 offset:8192
    v_mfma_f32_32x32x16_bf16 v[80:95], v[56:59], v[52:55], v[80:95]
    ds_read_b64_tr_b16 v[42:43], v12 offset:10240
    ds_read_b64_tr_b16 v[44:45], v13 offset:8192
    ds_read_b64_tr_b16 v[46:47], v13 offset:10240
    v_mfma_f32_32x32x16_bf16 v[96:111], v[60:63], v[48:51], v[96:111]
    v_mfma_f32_32x32x16_bf16 v[112:127], v[60:63], v[52:55], v[112:127]
    s_waitcnt lgkmcnt(0)
    v_mfma_f32_32x32x16_bf16 v[64:79], v[40:43], v[32:35], v[64:79]
    ds_read_b128 v[48:51], v9 offset:0
    ds_read_b128 v[52:55], v9 offset:4096
    ds_read_b64_tr_b16 v[56:57], v12 offset:12288
    v_mfma_f32_32x32x16_bf16 v[80:95], v[40:43], v[36:39], v[80:95]
    ds_read_b64_tr_b16 v[58:59], v12 offset:14336
    ds_read_b64_tr_b16 v[60:61], v13 offset:12288
    ds_read_b64_tr_b16 v[62:63], v13 offset:14336
    v_mfma_f32_32x32x16_bf16 v[96:111], v[44:47], v[32:35], v[96:111]
    v_mfma_f32_32x32x16_bf16 v[112:127], v[44:47], v[36:39], v[112:127]
    s_waitcnt lgkmcnt(0)
    v_mfma_f32_32x32x16_bf16 v[64:79], v[56:59], v[48:51], v[64:79]
    ds_read_b128 v[32:35], v6 offset:32768
    ds_read_b128 v[36:39], v6 offset:36864
    ds_read_b64_tr_b16 v[40:41], v12 offset:32768
    v_mfma_f32_32x32x16_bf16 v[80:95], v[56:59], v[52:55], v[80:95]
    ds_read_b64_tr_b16 v[42:43], v12 offset:34816
    ds_read_b64_tr_b16 v[44:45], v13 offset:32768
    ds_read_b64_tr_b16 v[46:47], v13 offset:34816
    v_mfma_f32_32x32x16_bf16 v[96:111], v[60:63], v[48:51], v[96:111]
    v_mfma_f32_32x32x16_bf16 v[112:127], v[60:63], v[52:55], v[112:127]
    s_waitcnt lgkmcnt(0)
    v_mfma_f32_32x32x16_bf16 v[64:79], v[40:43], v[32:35], v[64:79]
    ds_read_b128 v[48:51], v7 offset:32768
    ds_read_b128 v[52:55], v7 offset:36864
    ds_read_b64_tr_b16 v[56:57], v12 offset:36864
    v_mfma_f32_32x32x16_bf16 v[80:95], v[40:43], v[36:39], v[80:95]
    ds_read_b64_tr_b16 v[58:59], v12 offset:38912
    ds_read_b64_tr_b16 v[60:61], v13 offset:36864
    ds_read_b64_tr_b16 v[62:63], v13 offset:38912
    v_mfma_f32_32x32x16_bf16 v[96:111], v[44:47], v[32:35], v[96:111]
    v_mfma_f32_32x32x16_bf16 v[112:127], v[44:47], v[36:39], v[112:127]
    s_waitcnt lgkmcnt(0)
    v_mfma_f32_32x32x16_bf16 v[64:79], v[56:59], v[48:51], v[64:79]
    ds_read_b128 v[32:35], v8 offset:32768
    ds_read_b128 v[36:39], v8 offset:36864
    ds_read_b64_tr_b16 v[40:41], v12 offset:40960
    v_mfma_f32_32x32x16_bf16 v[80:95], v[56:59], v[52:55], v[80:95]
    ds_read_b64_tr_b16 v[42:43], v12 offset:43008
    ds_read_b64_tr_b16 v[44:45], v13 offset:40960
    ds_read_b64_tr_b16 v[46:47], v13 offset:43008
    v_mfma_f32_32x32x16_bf16 v[96:111], v[60:63], v[48:51], v[96:111]
    v_mfma_f32_32x32x16_bf16 v[112:127], v[60:63], v[52:55], v[112:127]
    s_waitcnt lgkmcnt(0)
    v_mfma_f32_32x32x16_bf16 v[64:79], v[40:43], v[32:35], v[64:79]
    ds_read_b128 v[48:51], v9 offset:32768
    ds_read_b128 v[52:55], v9 offset:36864
    ds_read_b64_tr_b16 v[56:57], v12 offset:45056
    v_mfma_f32_32x32x16_bf16 v[80:95], v[40:43], v[36:39], v[80:95]
    ds_read_b64_tr_b16 v[58:59], v12 offset:47104
    ds_read_b64_tr_b16 v[60:61], v13 offset:45056
    ds_read_b64_tr_b16 v[62:63], v13 offset:47104
    v_mfma_f32_32x32x16_bf16 v[96:111], v[44:47], v[32:35], v[96:111]
    v_mfma_f32_32x32x16_bf16 v[112:127], v[44:47], v[36:39], v[112:127]
    s_waitcnt lgkmcnt(0)
    v_mfma_f32_32x32x16_bf16 v[64:79], v[56:59], v[48:51], v[64:79]
    ds_read_b128 v[32:35], v2 offset:0
    ds_read_b128 v[36:39], v2 offset:4096
    ds_read_b64_tr_b16 v[40:41], v10 offset:0
    v_mfma_f32_32x32x16_bf16 v[80:95], v[56:59], v[52:55], v[80:95]
    ds_read_b64_tr_b16 v[42:43], v10 offset:2048
    ds_read_b64_tr_b16 v[44:45], v11 offset:0
    ds_read_b64_tr_b16 v[46:47], v11 offset:2048
    v_mfma_f32_32x32x16_bf16 v[96:111], v[60:63], v[48:51], v[96:111]
    v_mfma_f32_32x32x16_bf16 v[112:127], v[60:63], v[52:55], v[112:127]
    s_waitcnt lgkmcnt(0)
    v_mfma_f32_32x32x16_bf16 v[64:79], v[40:43], v[32:35], v[64:79]
    ds_read_b128 v[48:51], v3 offset:0
    ds_read_b128 v[52:55], v3 offset:4096
    ds_read_b64_tr_b16 v[56:57], v10 offset:4096
    v_mfma_f32_32x32x16_bf16 v[80:95], v[40:43], v[36:39], v[80:95]
    ds_read_b64_tr_b16 v[58:59], v10 offset:6144
    ds_read_b64_tr_b16 v[60:61], v11 offset:4096
    ds_read_b64_tr_b16 v[62:63], v11 offset:6144
    v_mfma_f32_32x32x16_bf16 v[96:111], v[44:47], v[32:35], v[96:111]
    v_mfma_f32_32x32x16_bf16 v[112:127], v[44:47], v[36:39], v[112:127]
    s_waitcnt lgkmcnt(0)
    v_mfma_f32_32x32x16_bf16 v[64:79], v[56:59], v[48:51], v[64:79]
    ds_read_b128 v[32:35], v4 offset:0
    ds_read_b128 v[36:39], v4 offset:4096
    ds_read_b64_tr_b16 v[40:41], v10 offset:8192
    v_mfma_f32_32x32x16_bf16 v[80:95], v[56:59], v[52:55], v[80:95]
    ds_read_b64_tr_b16 v[42:43], v10 offset:10240
    ds_read_b64_tr_b16 v[44:45], v11 offset:8192
    ds_read_b64_tr_b16 v[46:47], v11 offset:10240
    v_mfma_f32_32x32x16_bf16 v[96:111], v[60:63], v[48:51], v[96:111]
    v_mfma_f32_32x32x16_bf16 v[112:127], v[60:63], v[52:55], v[112:127]
    s_waitcnt lgkmcnt(0)
    v_mfma_f32_32x32x16_bf16 v[64:79], v[40:43], v[32:35], v[64:79]
    ds_read_b128 v[48:51], v5 offset:0
    ds_read_b128 v[52:55], v5 offset:4096
    ds_read_b64_tr_b16 v[56:57], v10 offset:12288
    v_mfma_f32_32x32x16_bf16 v[80:95], v[40:43], v[36:39], v[80:95]
    ds_read_b64_tr_b16 v[58:59], v10 offset:14336
    ds_read_b64_tr_b16 v[60:61], v11 offset:12288
    ds_read_b64_tr_b16 v[62:63], v11 offset:14336
    v_mfma_f32_32x32x16_bf16 v[96:111], v[44:47], v[32:35], v[96:111]
    v_mfma_f32_32x32x16_bf16 v[112:127], v[44:47], v[36:39], v[112:127]
    s_waitcnt lgkmcnt(0)
    v_mfma_f32_32x32x16_bf16 v[64:79], v[56:59], v[48:51], v[64:79]
    v_mfma_f32_32x32x16_bf16 v[80:95], v[56:59], v[52:55], v[80:95]
    v_mfma_f32_32x32x16_bf16 v[96:111], v[60:63], v[48:51], v[96:111]
    v_mfma_f32_32x32x16_bf16 v[112:127], v[60:63], v[52:55], v[112:127]
    s_lshl_b32 s58, s26, 2
    s_add_u32 s58, s58, 157552
    v_mov_b32 v20, s58
    v_mov_b32 v21, 1
    ds_write_b32 v20, v21
    s_nop 3
    v_cvt_pk_bf16_f32 v128, v64, v65
    v_cvt_pk_bf16_f32 v129, v66, v67
    v_cvt_pk_bf16_f32 v130, v68, v69
    v_cvt_pk_bf16_f32 v131, v70, v71
    buffer_store_dwordx4 v[128:131], v27, s[32:35], s74 offen offset:0 sc1
    v_cvt_pk_bf16_f32 v132, v72, v73
    v_cvt_pk_bf16_f32 v133, v74, v75
    v_cvt_pk_bf16_f32 v134, v76, v77
    v_cvt_pk_bf16_f32 v135, v78, v79
    buffer_store_dwordx4 v[132:135], v27, s[32:35], s74 offen offset:1024 sc1
    v_cvt_pk_bf16_f32 v136, v80, v81
    v_cvt_pk_bf16_f32 v137, v82, v83
    v_cvt_pk_bf16_f32 v138, v84, v85
    v_cvt_pk_bf16_f32 v139, v86, v87
    buffer_store_dwordx4 v[136:139], v27, s[32:35], s75 offen offset:0 sc1
    v_cvt_pk_bf16_f32 v140, v88, v89
    v_cvt_pk_bf16_f32 v141, v90, v91
    v_cvt_pk_bf16_f32 v142, v92, v93
    v_cvt_pk_bf16_f32 v143, v94, v95
    buffer_store_dwordx4 v[140:143], v27, s[32:35], s75 offen offset:1024 sc1
    v_cvt_pk_bf16_f32 v144, v96, v97
    v_cvt_pk_bf16_f32 v145, v98, v99
    v_cvt_pk_bf16_f32 v146, v100, v101
    v_cvt_pk_bf16_f32 v147, v102, v103
    buffer_store_dwordx4 v[144:147], v27, s[32:35], s74 offen offset:2048 sc1
    v_cvt_pk_bf16_f32 v148, v104, v105
    v_cvt_pk_bf16_f32 v149, v106, v107
    v_cvt_pk_bf16_f32 v150, v108, v109
    v_cvt_pk_bf16_f32 v151, v110, v111
    buffer_store_dwordx4 v[148:151], v27, s[32:35], s74 offen offset:3072 sc1
    v_cvt_pk_bf16_f32 v152, v112, v113
    v_cvt_pk_bf16_f32 v153, v114, v115
    v_cvt_pk_bf16_f32 v154, v116, v117
    v_cvt_pk_bf16_f32 v155, v118, v119
    buffer_store_dwordx4 v[152:155], v27, s[32:35], s75 offen offset:2048 sc1
    v_cvt_pk_bf16_f32 v156, v120, v121
    v_cvt_pk_bf16_f32 v157, v122, v123
    v_cvt_pk_bf16_f32 v158, v124, v125
    v_cvt_pk_bf16_f32 v159, v126, v127
    buffer_store_dwordx4 v[156:159], v27, s[32:35], s75 offen offset:3072 sc1
    v_lshlrev_b32 v3, 4, v0
    s_lshr_b32 s59, s78, 2
    s_mul_i32 s59, s59, 40960
    s_and_b32 s58, s78, 3
    s_lshl_b32 s58, s58, 7
    s_add_u32 s58, s58, s59
    s_mul_i32 s59, s26, 10240
    s_add_u32 s58, s58, s59
    s_add_u32 s67, s58, 18874368
    s_add_u32 s68, s67, 2621440
    s_add_u32 s69, s68, 2621440
    v_lshrrev_b32 v20, 3, v0
    v_and_b32 v21, 7, v0
    v_lshlrev_b32 v16, 9, v20
    v_lshl_add_u32 v16, v21, 4, v16
    v_add_u32 v17, 4096, v16
    v_add_u32 v18, 8192, v16
    s_mul_i32 s58, s26, 20
    v_add_u32 v20, s58, v20
    v_and_b32 v25, 1, v20
    v_lshrrev_b32 v6, 2, v20
    v_mul_u32_u24 v6, 144, v6
    v_lshl_add_u32 v6, v25, 4, v6
    v_bfe_u32 v25, v20, 1, 1
    v_lshl_add_u32 v6, v25, 6, v6
    v_mul_u32_u24 v25, 2880, v21
    v_add_u32 v6, v6, v25
    v_add_u32 v6, 98304, v6
    s_mov_b32 s70, 0xbfb8aa3b
    s_mov_b32 s71, 0xbfb8aa3b
    v_mov_b32 v30, 1.0
    v_mov_b32 v31, 1.0
    v_min_u32 v19, 29, v0
    v_lshlrev_b32 v19, 7, v19
    s_lshr_b32 s72, s78, 3
    s_lshl_b32 s72, s72, 12
    s_add_u32 s72, s72, 589824
    s_waitcnt vmcnt(0)
    v_mov_b32 v22, s27
    v_mov_b32 v23, 0
    s_mov_b64 exec, 1
    buffer_store_dword v22, v23, s[48:51], s76 offen sc1
    s_mov_b64 exec, -1
    s_branch Le
Lc2ng:
    v_mov_b32 v24, 157504
    v_mov_b32 v20, 1
    v_mov_b32 v21, 1
    v_mov_b32 v22, 1
    v_mov_b32 v23, 1
    ds_write_b128 v24, v[20:23]
    s_waitcnt lgkmcnt(0)
    s_barrier
    s_barrier
    s_barrier
    s_barrier
    s_barrier
    s_barrier
    s_barrier
    s_lshl_b32 s58, s26, 2
    s_add_u32 s58, s58, 157552
    v_mov_b32 v20, s58
    v_mov_b32 v21, 1
    ds_write_b32 v20, v21
    v_lshlrev_b32 v3, 4, v0
    s_lshr_b32 s59, s78, 2
    s_mul_i32 s59, s59, 40960
    s_and_b32 s58, s78, 3
    s_lshl_b32 s58, s58, 7
    s_add_u32 s58, s58, s59
    s_mul_i32 s59, s26, 10240
    s_add_u32 s58, s58, s59
    s_add_u32 s67, s58, 18874368
    s_add_u32 s68, s67, 2621440
    s_add_u32 s69, s68, 2621440
    v_lshrrev_b32 v20, 3, v0
    v_and_b32 v21, 7, v0
    v_lshlrev_b32 v16, 9, v20
    v_lshl_add_u32 v16, v21, 4, v16
    v_add_u32 v17, 4096, v16
    v_add_u32 v18, 8192, v16
    s_mul_i32 s58, s26, 20
    v_add_u32 v20, s58, v20
    v_and_b32 v25, 1, v20
    v_lshrrev_b32 v6, 2, v20
    v_mul_u32_u24 v6, 144, v6
    v_lshl_add_u32 v6, v25, 4, v6
    v_bfe_u32 v25, v20, 1, 1
    v_lshl_add_u32 v6, v25, 6, v6
    v_mul_u32_u24 v25, 2880, v21
    v_add_u32 v6, v6, v25
    v_add_u32 v6, 98304, v6
    s_mov_b32 s70, 0xbfb8aa3b
    s_mov_b32 s71, 0xbfb8aa3b
    v_mov_b32 v30, 1.0
    v_mov_b32 v31, 1.0
    v_min_u32 v19, 29, v0
    v_lshlrev_b32 v19, 7, v19
    s_lshr_b32 s72, s78, 3
    s_lshl_b32 s72, s72, 12
    s_add_u32 s72, s72, 589824
    s_waitcnt vmcnt(0)
Le:
    s_cmp_lg_u32 s26, 0
    s_cbranch_scc1 Lpo_11_w
    s_mov_b32 s30, 0
Lpo_11:
    buffer_load_dword v22, v19, s[48:51], s72 offen offset:0 sc1
    s_waitcnt vmcnt(0)
    v_xor_b32 v22, s27, v22
    v_cmp_eq_u32 vcc, 0, v22
    s_nop 0
    s_cmp_eq_u64 vcc, -1
    s_cbranch_scc1 Lpo_11_ok
    s_add_u32 s30, s30, 1
    s_cmp_ge_u32 s30, 40000
    s_cbranch_scc1 Lpo_11_ok
    s_sleep 4
    s_branch Lpo_11
Lpo_11_ok:
    v_mov_b32 v26, 157568
    v_mov_b32 v22, 1
    v_mov_b32 v23, 1
    v_mov_b32 v24, 1
    v_mov_b32 v25, 1
    ds_write_b128 v26, v[22:25]
Lpo_11_w:
    v_mov_b32 v26, 157568
    s_mov_b32 s30, 0
Lfw_12:
    ds_read_b128 v[22:25], v26
    s_waitcnt lgkmcnt(0)
    v_and_b32 v22, v22, v23
    v_and_b32 v24, v24, v25
    v_and_b32 v22, v22, v24
    s_nop 0
    v_readfirstlane_b32 s58, v22
    s_add_u32 s30, s30, 1
    s_cmp_ge_u32 s30, 320000
    s_cselect_b32 s58, 1, s58
    s_cmp_eq_u32 s58, 0
    s_cbranch_scc1 Lfw_12
    buffer_load_dwordx4 v[32:35], v16, s[48:51], s67 offen sc1
    buffer_load_dwordx4 v[36:39], v16, s[48:51], s68 offen sc1
    buffer_load_dwordx4 v[40:43], v16, s[48:51], s69 offen sc1
    buffer_load_dwordx4 v[44:47], v17, s[48:51], s67 offen sc1
    buffer_load_dwordx4 v[48:51], v17, s[48:51], s68 offen sc1
    buffer_load_dwordx4 v[52:55], v17, s[48:51], s69 offen sc1
    s_mov_b32 exec_hi, 0
    buffer_load_dwordx4 v[56:59], v18, s[48:51], s67 offen sc1
    buffer_load_dwordx4 v[60:63], v18, s[48:51], s68 offen sc1
    buffer_load_dwordx4 v[64:67], v18, s[48:51], s69 offen sc1
    s_mov_b64 exec, -1
    v_mov_b32 v26, 157552
    s_mov_b32 s30, 0
Lfw_13:
    ds_read_b128 v[22:25], v26
    s_waitcnt lgkmcnt(0)
    v_and_b32 v22, v22, v23
    v_and_b32 v24, v24, v25
    v_and_b32 v22, v22, v24
    s_nop 0
    v_readfirstlane_b32 s58, v22
    s_add_u32 s30, s30, 1
    s_cmp_ge_u32 s30, 320000
    s_cselect_b32 s58, 1, s58
    s_cmp_eq_u32 s58, 0
    s_cbranch_scc1 Lfw_13
    s_waitcnt vmcnt(6)
    v_lshlrev_b32 v96, 16, v32
    v_and_b32 v97, 0xffff0000, v32
    v_lshlrev_b32 v98, 16, v36
    v_and_b32 v99, 0xffff0000, v36
    v_lshlrev_b32 v100, 16, v40
    v_and_b32 v101, 0xffff0000, v40
    v_lshlrev_b32 v104, 16, v33
    v_and_b32 v105, 0xffff0000, v33
    v_lshlrev_b32 v106, 16, v37
    v_and_b32 v107, 0xffff0000, v37
    v_lshlrev_b32 v108, 16, v41
    v_and_b32 v109, 0xffff0000, v41
    v_lshlrev_b32 v112, 16, v34
    v_and_b32 v113, 0xffff0000, v34
    v_lshlrev_b32 v114, 16, v38
    v_and_b32 v115, 0xffff0000, v38
    v_lshlrev_b32 v116, 16, v42
    v_and_b32 v117, 0xffff0000, v42
    v_lshlrev_b32 v120, 16, v35
    v_and_b32 v121, 0xffff0000, v35
    v_lshlrev_b32 v122, 16, v39
    v_and_b32 v123, 0xffff0000, v39
    v_lshlrev_b32 v124, 16, v43
    v_and_b32 v125, 0xffff0000, v43
    v_pk_add_f32 v[96:97], v[96:97], v[98:99]
    v_pk_add_f32 v[104:105], v[104:105], v[106:107]
    v_pk_add_f32 v[112:113], v[112:113], v[114:115]
    v_pk_add_f32 v[120:121], v[120:121], v[122:123]
    v_pk_add_f32 v[128:129], v[96:97], v[100:101]
    v_pk_add_f32 v[130:131], v[104:105], v[108:109]
    v_pk_add_f32 v[132:133], v[112:113], v[116:117]
    v_pk_add_f32 v[134:135], v[120:121], v[124:125]
    v_pk_mul_f32 v[152:153], v[128:129], s[70:71]
    v_pk_mul_f32 v[154:155], v[130:131], s[70:71]
    v_pk_mul_f32 v[156:157], v[132:133], s[70:71]
    v_pk_mul_f32 v[158:159], v[134:135], s[70:71]
    v_exp_f32 v152, v152
    v_exp_f32 v153, v153
    v_exp_f32 v154, v154
    v_exp_f32 v155, v155
    v_exp_f32 v156, v156
    v_exp_f32 v157, v157
    v_exp_f32 v158, v158
    v_exp_f32 v159, v159
    v_pk_add_f32 v[152:153], v[152:153], v[30:31]
    v_pk_add_f32 v[154:155], v[154:155], v[30:31]
    v_pk_add_f32 v[156:157], v[156:157], v[30:31]
    v_pk_add_f32 v[158:159], v[158:159], v[30:31]
    v_rcp_f32 v152, v152
    v_rcp_f32 v153, v153
    v_rcp_f32 v154, v154
    v_rcp_f32 v155, v155
    v_rcp_f32 v156, v156
    v_rcp_f32 v157, v157
    v_rcp_f32 v158, v158
    v_rcp_f32 v159, v159
    v_pk_mul_f32 v[128:129], v[128:129], v[152:153]
    v_pk_mul_f32 v[130:131], v[130:131], v[154:155]
    v_pk_mul_f32 v[132:133], v[132:133], v[156:157]
    v_pk_mul_f32 v[134:135], v[134:135], v[158:159]
    ds_write_b128 v6, v[128:131] offset:0
    ds_write_b128 v6, v[132:135] offset:32
    s_waitcnt vmcnt(3)
    v_lshlrev_b32 v96, 16, v44
    v_and_b32 v97, 0xffff0000, v44
    v_lshlrev_b32 v98, 16, v48
    v_and_b32 v99, 0xffff0000, v48
    v_lshlrev_b32 v100, 16, v52
    v_and_b32 v101, 0xffff0000, v52
    v_lshlrev_b32 v104, 16, v45
    v_and_b32 v105, 0xffff0000, v45
    v_lshlrev_b32 v106, 16, v49
    v_and_b32 v107, 0xffff0000, v49
    v_lshlrev_b32 v108, 16, v53
    v_and_b32 v109, 0xffff0000, v53
    v_lshlrev_b32 v112, 16, v46
    v_and_b32 v113, 0xffff0000, v46
    v_lshlrev_b32 v114, 16, v50
    v_and_b32 v115, 0xffff0000, v50
    v_lshlrev_b32 v116, 16, v54
    v_and_b32 v117, 0xffff0000, v54
    v_lshlrev_b32 v120, 16, v47
    v_and_b32 v121, 0xffff0000, v47
    v_lshlrev_b32 v122, 16, v51
    v_and_b32 v123, 0xffff0000, v51
    v_lshlrev_b32 v124, 16, v55
    v_and_b32 v125, 0xffff0000, v55
    v_pk_add_f32 v[96:97], v[96:97], v[98:99]
    v_pk_add_f32 v[104:105], v[104:105], v[106:107]
    v_pk_add_f32 v[112:113], v[112:113], v[114:115]
    v_pk_add_f32 v[120:121], v[120:121], v[122:123]
    v_pk_add_f32 v[136:137], v[96:97], v[100:101]
    v_pk_add_f32 v[138:139], v[104:105], v[108:109]
    v_pk_add_f32 v[140:141], v[112:113], v[116:117]
    v_pk_add_f32 v[142:143], v[120:121], v[124:125]
    v_pk_mul_f32 v[152:153], v[136:137], s[70:71]
    v_pk_mul_f32 v[154:155], v[138:139], s[70:71]
    v_pk_mul_f32 v[156:157], v[140:141], s[70:71]
    v_pk_mul_f32 v[158:159], v[142:143], s[70:71]
    v_exp_f32 v152, v152
    v_exp_f32 v153, v153
    v_exp_f32 v154, v154
    v_exp_f32 v155, v155
    v_exp_f32 v156, v156
    v_exp_f32 v157, v157
    v_exp_f32 v158, v158
    v_exp_f32 v159, v159
    v_pk_add_f32 v[152:153], v[152:153], v[30:31]
    v_pk_add_f32 v[154:155], v[154:155], v[30:31]
    v_pk_add_f32 v[156:157], v[156:157], v[30:31]
    v_pk_add_f32 v[158:159], v[158:159], v[30:31]
    v_rcp_f32 v152, v152
    v_rcp_f32 v153, v153
    v_rcp_f32 v154, v154
    v_rcp_f32 v155, v155
    v_rcp_f32 v156, v156
    v_rcp_f32 v157, v157
    v_rcp_f32 v158, v158
    v_rcp_f32 v159, v159
    v_pk_mul_f32 v[136:137], v[136:137], v[152:153]
    v_pk_mul_f32 v[138:139], v[138:139], v[154:155]
    v_pk_mul_f32 v[140:141], v[140:141], v[156:157]
    v_pk_mul_f32 v[142:143], v[142:143], v[158:159]
    ds_write_b128 v6, v[136:139] offset:288
    ds_write_b128 v6, v[140:143] offset:320
    s_waitcnt vmcnt(0)
    v_lshlrev_b32 v96, 16, v56
    v_and_b32 v97, 0xffff0000, v56
    v_lshlrev_b32 v98, 16, v60
    v_and_b32 v99, 0xffff0000, v60
    v_lshlrev_b32 v100, 16, v64
    v_and_b32 v101, 0xffff0000, v64
    v_lshlrev_b32 v104, 16, v57
    v_and_b32 v105, 0xffff0000, v57
    v_lshlrev_b32 v106, 16, v61
    v_and_b32 v107, 0xffff0000, v61
    v_lshlrev_b32 v108, 16, v65
    v_and_b32 v109, 0xffff0000, v65
    v_lshlrev_b32 v112, 16, v58
    v_and_b32 v113, 0xffff0000, v58
    v_lshlrev_b32 v114, 16, v62
    v_and_b32 v115, 0xffff0000, v62
    v_lshlrev_b32 v116, 16, v66
    v_and_b32 v117, 0xffff0000, v66
    v_lshlrev_b32 v120, 16, v59
    v_and_b32 v121, 0xffff0000, v59
    v_lshlrev_b32 v122, 16, v63
    v_and_b32 v123, 0xffff0000, v63
    v_lshlrev_b32 v124, 16, v67
    v_and_b32 v125, 0xffff0000, v67
    v_pk_add_f32 v[96:97], v[96:97], v[98:99]
    v_pk_add_f32 v[104:105], v[104:105], v[106:107]
    v_pk_add_f32 v[112:113], v[112:113], v[114:115]
    v_pk_add_f32 v[120:121], v[120:121], v[122:123]
    v_pk_add_f32 v[144:145], v[96:97], v[100:101]
    v_pk_add_f32 v[146:147], v[104:105], v[108:109]
    v_pk_add_f32 v[148:149], v[112:113], v[116:117]
    v_pk_add_f32 v[150:151], v[120:121], v[124:125]
    v_pk_mul_f32 v[152:153], v[144:145], s[70:71]
    v_pk_mul_f32 v[154:155], v[146:147], s[70:71]
    v_pk_mul_f32 v[156:157], v[148:149], s[70:71]
    v_pk_mul_f32 v[158:159], v[150:151], s[70:71]
    v_exp_f32 v152, v152
    v_exp_f32 v153, v153
    v_exp_f32 v154, v154
    v_exp_f32 v155, v155
    v_exp_f32 v156, v156
    v_exp_f32 v157, v157
    v_exp_f32 v158, v158
    v_exp_f32 v159, v159
    v_pk_add_f32 v[152:153], v[152:153], v[30:31]
    v_pk_add_f32 v[154:155], v[154:155], v[30:31]
    v_pk_add_f32 v[156:157], v[156:157], v[30:31]
    v_pk_add_f32 v[158:159], v[158:159], v[30:31]
    v_rcp_f32 v152, v152
    v_rcp_f32 v153, v153
    v_rcp_f32 v154, v154
    v_rcp_f32 v155, v155
    v_rcp_f32 v156, v156
    v_rcp_f32 v157, v157
    v_rcp_f32 v158, v158
    v_rcp_f32 v159, v159
    v_pk_mul_f32 v[144:145], v[144:145], v[152:153]
    v_pk_mul_f32 v[146:147], v[146:147], v[154:155]
    v_pk_mul_f32 v[148:149], v[148:149], v[156:157]
    v_pk_mul_f32 v[150:151], v[150:151], v[158:159]
    s_mov_b32 exec_hi, 0
    ds_write_b128 v6, v[144:147] offset:576
    ds_write_b128 v6, v[148:151] offset:608
    s_mov_b64 exec, -1
    v_lshrrev_b32 v4, 2, v0
    v_mul_u32_u24 v4, 144, v4
    v_and_b32 v5, 3, v0
    v_lshl_add_u32 v4, v5, 5, v4
    v_add_u32 v4, s81, v4
    s_mov_b32 s36, s20
    s_mov_b32 s37, s21
    s_mov_b32 s38, 2621440
    s_mov_b32 s39, 0x00020000
    v_lshlrev_b32 v96, 16, v160
    v_and_b32 v97, 0xffff0000, v160
    v_lshlrev_b32 v98, 16, v161
    v_and_b32 v99, 0xffff0000, v161
    v_lshlrev_b32 v100, 16, v162
    v_and_b32 v101, 0xffff0000, v162
    v_lshlrev_b32 v102, 16, v163
    v_and_b32 v103, 0xffff0000, v163
    v_lshlrev_b32 v104, 16, v164
    v_and_b32 v105, 0xffff0000, v164
    v_lshlrev_b32 v106, 16, v165
    v_and_b32 v107, 0xffff0000, v165
    v_lshlrev_b32 v108, 16, v166
    v_and_b32 v109, 0xffff0000, v166
    v_lshlrev_b32 v110, 16, v167
    v_and_b32 v111, 0xffff0000, v167
    s_branch Lfin
Lload:
    s_sub_u32 s26, s26, 8
    s_cmp_ge_u32 s61, 28
    s_cbranch_scc1 Lwj_l
    s_setprio 2
    s_lshl_b32 s66, s62, 2
    s_add_u32 s66, s66, s26
    s_mul_i32 s66, s66, 20480
    s_mul_i32 s67, s26, 55296
    s_lshl_b32 s59, s63, 8
    s_add_u32 s67, s67, s59
    s_lshl_b32 s68, s26, 12
    v_bfe_u32 v20, v0, 3, 2
    v_lshrrev_b32 v21, 5, v0
    v_lshl_add_u32 v20, v21, 10, v20
    v_mul_u32_u24 v20, 1280, v20
    v_lshrrev_b32 v21, 4, v0
    v_and_b32 v22, 7, v0
    v_xor_b32 v21, v21, v22
    v_lshl_add_u32 v2, v21, 4, v20
    v_xor_b32 v21, 4, v21
    v_lshl_add_u32 v23, v21, 4, v20
    v_add_u32 v3, 4096, v23
    v_add_u32 v4, 8192, v2
    v_add_u32 v5, 12288, v23
    v_lshrrev_b32 v20, 4, v0
    v_bfe_u32 v21, v0, 2, 2
    v_xor_b32 v21, v21, v20
    v_lshlrev_b32 v21, 2, v21
    v_and_b32 v22, 3, v0
    v_add_u32 v21, v21, v22
    v_lshlrev_b32 v21, 4, v21
    v_mul_u32_u24 v20, 3456, v20
    v_add_u32 v6, v20, v21
    v_add_u32 v7, 12800, v6
    v_add_u32 v8, 25600, v6
    v_add_u32 v9, 38400, v6
    s_waitcnt lgkmcnt(0)
    s_mov_b32 s32, s4
    s_mov_b32 s33, s5
    s_mov_b32 s34, 2621440
    s_mov_b32 s35, 0x00020000
    s_mov_b32 s36, s12
    s_mov_b32 s37, s13
    s_mov_b32 s38, 2211840
    s_mov_b32 s39, 0x00020000
    s_barrier
    s_add_u32 m0, s68, 0
    s_nop 0
    buffer_load_dwordx4 v2, s[32:35], s66 offen offset:0 lds
    buffer_load_dwordx4 v3, s[32:35], s66 offen offset:1024 lds
    buffer_load_dwordx4 v4, s[32:35], s66 offen offset:2048 lds
    buffer_load_dwordx4 v5, s[32:35], s66 offen offset:3072 lds
    s_add_u32 m0, s68, 16384
    s_nop 0
    buffer_load_dwordx4 v6, s[36:39], s67 offen offset:0 lds
    buffer_load_dwordx4 v7, s[36:39], s67 offen offset:1024 lds
    buffer_load_dwordx4 v8, s[36:39], s67 offen offset:2048 lds
    buffer_load_dwordx4 v9, s[36:39], s67 offen offset:3072 lds
    s_add_u32 s66, s66, 128
    s_add_u32 s67, s67, 221184
    s_add_u32 m0, s68, 32768
    s_nop 0
    buffer_load_dwordx4 v2, s[32:35], s66 offen offset:0 lds
    buffer_load_dwordx4 v3, s[32:35], s66 offen offset:1024 lds
    buffer_load_dwordx4 v4, s[32:35], s66 offen offset:2048 lds
    buffer_load_dwordx4 v5, s[32:35], s66 offen offset:3072 lds
    s_add_u32 m0, s68, 49152
    s_nop 0
    buffer_load_dwordx4 v6, s[36:39], s67 offen offset:0 lds
    buffer_load_dwordx4 v7, s[36:39], s67 offen offset:1024 lds
    buffer_load_dwordx4 v8, s[36:39], s67 offen offset:2048 lds
    buffer_load_dwordx4 v9, s[36:39], s67 offen offset:3072 lds
    s_add_u32 s66, s66, 128
    s_add_u32 s67, s67, 221184
    s_add_u32 m0, s68, 65536
    s_nop 0
    buffer_load_dwordx4 v2, s[32:35], s66 offen offset:0 lds
    buffer_load_dwordx4 v3, s[32:35], s66 offen offset:1024 lds
    buffer_load_dwordx4 v4, s[32:35], s66 offen offset:2048 lds
    buffer_load_dwordx4 v5, s[32:35], s66 offen offset:3072 lds
    s_add_u32 m0, s68, 81920
    s_nop 0
    buffer_load_dwordx4 v6, s[36:39], s67 offen offset:0 lds
    buffer_load_dwordx4 v7, s[36:39], s67 offen offset:1024 lds
    buffer_load_dwordx4 v8, s[36:39], s67 offen offset:2048 lds
    buffer_load_dwordx4 v9, s[36:39], s67 offen offset:3072 lds
    s_add_u32 s66, s66, 128
    s_add_u32 s67, s67, 221184
    s_setprio 0
    v_lshlrev_b32 v24, 4, v0
    v_add_u32 v24, 120832, v24
    ds_read_b128 v[64:67], v24 offset:0
    ds_read_b128 v[68:71], v24 offset:1024
    ds_read_b128 v[72:75], v24 offset:2048
    ds_read_b128 v[76:79], v24 offset:3072
    ds_read_b128 v[80:83], v24 offset:4096
    ds_read_b128 v[84:87], v24 offset:5120
    ds_read_b128 v[88:91], v24 offset:6144
    ds_read_b128 v[92:95], v24 offset:7168
    v_lshrrev_b32 v20, 5, v0
    v_and_b32 v21, 31, v0
    v_cvt_f32_u32 v26, v20
    v_mul_f32 v26, 4.0, v26
    v_cvt_f32_u32 v27, v21
    v_mul_f32 v22, 0x3a800000, v27
    v_mul_f32 v24, v26, v22
    v_fmamk_f32 v112, v22, 0x00000000, v24
    v_fmamk_f32 v113, v22, 0x3f800000, v24
    v_fmamk_f32 v114, v22, 0x40000000, v24
    v_fmamk_f32 v115, v22, 0x40400000, v24
    v_fmamk_f32 v116, v22, 0x41000000, v24
    v_fmamk_f32 v117, v22, 0x41100000, v24
    v_fmamk_f32 v118, v22, 0x41200000, v24
    v_fmamk_f32 v119, v22, 0x41300000, v24
    v_fmamk_f32 v120, v22, 0x41800000, v24
    v_fmamk_f32 v121, v22, 0x41880000, v24
    v_fmamk_f32 v122, v22, 0x41900000, v24
    v_fmamk_f32 v123, v22, 0x41980000, v24
    v_fmamk_f32 v124, v22, 0x41c00000, v24
    v_fmamk_f32 v125, v22, 0x41c80000, v24
    v_fmamk_f32 v126, v22, 0x41d00000, v24
    v_fmamk_f32 v127, v22, 0x41d80000, v24
    v_cos_f32 v96, v112
    v_sin_f32 v112, v112
    v_cos_f32 v97, v113
    v_sin_f32 v113, v113
    v_cos_f32 v98, v114
    v_sin_f32 v114, v114
    v_cos_f32 v99, v115
    v_sin_f32 v115, v115
    v_cos_f32 v100, v116
    v_sin_f32 v116, v116
    v_cos_f32 v101, v117
    v_sin_f32 v117, v117
    v_cos_f32 v102, v118
    v_sin_f32 v118, v118
    v_cos_f32 v103, v119
    v_sin_f32 v119, v119
    v_cos_f32 v104, v120
    v_sin_f32 v120, v120
    v_cos_f32 v105, v121
    v_sin_f32 v121, v121
    v_cos_f32 v106, v122
    v_sin_f32 v122, v122
    v_cos_f32 v107, v123
    v_sin_f32 v123, v123
    v_cos_f32 v108, v124
    v_sin_f32 v124, v124
    v_cos_f32 v109, v125
    v_sin_f32 v125, v125
    v_cos_f32 v110, v126
    v_sin_f32 v126, v126
    v_cos_f32 v111, v127
    v_sin_f32 v127, v127
    v_cmp_lt_u32 vcc, 15, v21
    v_mov_b32 v22, 0x80008000
    s_nop 0
    v_cndmask_b32 v22, 0, v22, vcc
    s_waitcnt lgkmcnt(0)
    v_xor_b32 v80, v22, v80
    v_xor_b32 v81, v22, v81
    v_xor_b32 v82, v22, v82
    v_xor_b32 v83, v22, v83
    v_xor_b32 v84, v22, v84
    v_xor_b32 v85, v22, v85
    v_xor_b32 v86, v22, v86
    v_xor_b32 v87, v22, v87
    v_xor_b32 v88, v22, v88
    v_xor_b32 v89, v22, v89
    v_xor_b32 v90, v22, v90
    v_xor_b32 v91, v22, v91
    v_xor_b32 v92, v22, v92
    v_xor_b32 v93, v22, v93
    v_xor_b32 v94, v22, v94
    v_xor_b32 v95, v22, v95
    s_mul_i32 s64, s62, 40
    s_mul_i32 s58, s26, 12
    s_add_u32 s64, s64, s58
    s_mul_i32 s64, s64, 3456
    s_lshl_b32 s58, s63, 8
    s_add_u32 s64, s64, s58
    s_mul_i32 s65, s26, 3072
    s_add_u32 s65, s65, 141952
    s_mov_b32 s40, s22
    s_mov_b32 s41, s23
    s_mov_b32 s42, 256
    s_mov_b32 s43, 0x00020000
    s_mov_b32 s48, s24
    s_mov_b32 s49, s25
    s_mov_b32 s50, 33554432
    s_mov_b32 s51, 0x00020000
    s_lshl_b32 s71, s60, 4
    s_lshr_b32 s59, s61, 1
    s_add_u32 s71, s71, s59
    s_mul_i32 s71, s71, 20736
    s_and_b32 s59, s61, 1
    s_lshl_b32 s59, s59, 6
    s_add_u32 s71, s71, s59
    v_lshrrev_b32 v20, 5, v0
    v_bfe_u32 v22, v0, 2, 2
    v_lshl_add_u32 v23, v20, 3, v22
    v_lshlrev_b32 v23, 8, v23
    v_bfe_u32 v24, v0, 4, 1
    v_lshl_add_u32 v23, v24, 5, v23
    v_and_b32 v24, 3, v0
    v_lshl_add_u32 v23, v24, 3, v23
    v_xor_b32 v24, s26, v22
    v_lshl_add_u32 v23, v24, 6, v23
    v_add_u32 v23, 141952, v23
    v_mov_b32 v28, 0x3f803f80
    v_mov_b32 v29, 0x3f803f80
    v_mov_b32 v30, 0x3f803f80
    v_mov_b32 v31, 0x3f803f80
    v_cmp_gt_u32 vcc, 32, v0
    s_nop 1
    v_cndmask_b32 v44, 0, v28, vcc
    v_cndmask_b32 v45, 0, v28, vcc
    v_cndmask_b32 v46, 0, v28, vcc
    v_cndmask_b32 v47, 0, v28, vcc
    s_lshl_b32 s59, s26, 6
    s_add_u32 s72, s71, 1048576
    v_add_u32 v132, s59, v0
    v_cmp_lt_u32 vcc, 0x143, v132
    s_nop 1
    v_cndmask_b32_e64 v136, 0, 1, vcc
    v_mul_u32_u24 v133, 324, v136
    v_sub_u32 v133, v132, v133
    v_and_b32 v134, 3, v132
    v_lshlrev_b32 v135, 5, v132
    v_lshlrev_b32 v134, 4, v134
    v_sub_u32 v135, v135, v134
    v_mul_u32_u24 v134, 3277, v133
    v_lshrrev_b32 v134, 16, v134
    v_add_u32 v133, v133, v134
    v_min_u32 v133, 335, v133
    v_mul_u32_u24 v134, 5440, v136
    v_lshl_add_u32 v133, v133, 2, v134
    v_add_u32 v133, 131072, v133
    v_add_u32 v140, s59, v0
    v_add_u32 v140, 256, v140
    v_cmp_lt_u32 vcc, 0x143, v140
    s_nop 1
    v_cndmask_b32_e64 v144, 0, 1, vcc
    v_mul_u32_u24 v141, 324, v144
    v_sub_u32 v141, v140, v141
    v_and_b32 v142, 3, v140
    v_lshlrev_b32 v143, 5, v140
    v_lshlrev_b32 v142, 4, v142
    v_sub_u32 v143, v143, v142
    v_mul_u32_u24 v142, 3277, v141
    v_lshrrev_b32 v142, 16, v142
    v_add_u32 v141, v141, v142
    v_min_u32 v141, 335, v141
    v_mul_u32_u24 v142, 5440, v144
    v_lshl_add_u32 v141, v141, 2, v142
    v_add_u32 v141, 131072, v141
    v_add_u32 v148, s59, v0
    v_add_u32 v148, 512, v148
    v_cmp_lt_u32 vcc, 0x143, v148
    s_nop 1
    v_cndmask_b32_e64 v152, 0, 1, vcc
    v_mul_u32_u24 v149, 324, v152
    v_sub_u32 v149, v148, v149
    v_and_b32 v150, 3, v148
    v_lshlrev_b32 v151, 5, v148
    v_lshlrev_b32 v150, 4, v150
    v_sub_u32 v151, v151, v150
    v_mul_u32_u24 v150, 3277, v149
    v_lshrrev_b32 v150, 16, v150
    v_add_u32 v149, v149, v150
    v_min_u32 v149, 335, v149
    v_mul_u32_u24 v150, 5440, v152
    v_lshl_add_u32 v149, v149, 2, v150
    v_add_u32 v149, 131072, v149
    v_mov_b32 v18, 2146435072
    v_cmp_gt_u32 vcc, 0x288, v148
    s_nop 1
    v_cndmask_b32 v151, v18, v151, vcc
    s_lshl_b32 s73, s60, 2
    s_add_u32 s73, s73, s26
    s_lshl_b32 s73, s73, 5
    s_add_u32 s73, s73, s61
    s_and_b32 s59, s73, 3
    s_lshl_b32 s73, s73, 1
    s_sub_u32 s73, s73, s59
    s_lshl_b32 s73, s73, 4
    v_and_b32 v156, 1, v0
    v_lshlrev_b32 v157, 6, v156
    v_lshlrev_b32 v156, 3, v156
    s_lshl_b32 s59, s26, 4
    s_add_u32 s59, s59, 157600
    v_add_u32 v156, s59, v156
    s_lshl_b32 s74, s60, 5
    s_add_u32 s74, s74, s61
    s_lshl_b32 s74, s74, 4
    s_add_u32 s74, s74, 720896
    s_lshr_b32 s76, s62, 1
    s_mul_i32 s76, s76, 1792
    s_lshl_b32 s59, s63, 7
    s_add_u32 s76, s76, s59
    s_lshl_b32 s59, s26, 5
    s_add_u32 s76, s76, s59
    s_lshl_b32 s76, s76, 1
    s_and_b32 s59, s62, 1
    s_add_u32 s76, s76, s59
    s_lshl_b32 s76, s76, 3
    s_add_u32 s76, s76, 65536
    s_setprio 2
    s_waitcnt vmcnt(16)
    s_barrier
    s_add_u32 m0, s68, 98304
    s_nop 0
    buffer_load_dwordx4 v2, s[32:35], s66 offen offset:0 lds
    buffer_load_dwordx4 v3, s[32:35], s66 offen offset:1024 lds
    buffer_load_dwordx4 v4, s[32:35], s66 offen offset:2048 lds
    buffer_load_dwordx4 v5, s[32:35], s66 offen offset:3072 lds
    s_add_u32 m0, s68, 114688
    s_nop 0
    buffer_load_dwordx4 v6, s[36:39], s67 offen offset:0 lds
    buffer_load_dwordx4 v7, s[36:39], s67 offen offset:1024 lds
    buffer_load_dwordx4 v8, s[36:39], s67 offen offset:2048 lds
    buffer_load_dwordx4 v9, s[36:39], s67 offen offset:3072 lds
    s_add_u32 s66, s66, 128
    s_add_u32 s67, s67, 221184
    ds_read_b32 v136, v133 offset:0
    ds_read_b32 v137, v133 offset:1360
    ds_read_b32 v138, v133 offset:2720
    ds_read_b32 v139, v133 offset:4080
    ds_read_b32 v144, v141 offset:0
    ds_read_b32 v145, v141 offset:1360
    ds_read_b32 v146, v141 offset:2720
    ds_read_b32 v147, v141 offset:4080
    ds_read_b32 v152, v149 offset:0
    ds_read_b32 v153, v149 offset:1360
    ds_read_b32 v154, v149 offset:2720
    ds_read_b32 v155, v149 offset:4080
    ds_read_b32 v160, v156
    ds_read_b32 v162, v156 offset:4
    s_waitcnt vmcnt(16)
    s_barrier
    s_add_u32 m0, s68, 0
    s_nop 0
    buffer_load_dwordx4 v2, s[32:35], s66 offen offset:0 lds
    buffer_load_dwordx4 v3, s[32:35], s66 offen offset:1024 lds
    buffer_load_dwordx4 v4, s[32:35], s66 offen offset:2048 lds
    buffer_load_dwordx4 v5, s[32:35], s66 offen offset:3072 lds
    s_add_u32 m0, s68, 16384
    s_nop 0
    buffer_load_dwordx4 v6, s[36:39], s67 offen offset:0 lds
    buffer_load_dwordx4 v7, s[36:39], s67 offen offset:1024 lds
    buffer_load_dwordx4 v8, s[36:39], s67 offen offset:2048 lds
    buffer_load_dwordx4 v9, s[36:39], s67 offen offset:3072 lds
    s_add_u32 s66, s66, 128
    s_add_u32 s67, s67, 221184
    s_waitcnt lgkmcnt(0)
    buffer_store_dwordx4 v[136:139], v135, s[48:51], s72 offen sc1
    buffer_store_dwordx4 v[144:147], v143, s[48:51], s72 offen sc1
    buffer_store_dwordx4 v[152:155], v151, s[48:51], s72 offen sc1
    s_mov_b32 m0, s65
    s_nop 0
    buffer_load_dwordx4 v6, s[36:39], s64 offen offset:0 lds
    buffer_load_dwordx4 v7, s[36:39], s64 offen offset:1024 lds
    buffer_load_dwordx4 v8, s[36:39], s64 offen offset:2048 lds
    v_mov_b32 v15, 0
    buffer_load_dword v14, v15, s[40:43], 0 offen sc1
    s_waitcnt vmcnt(23)
    s_barrier
    s_add_u32 m0, s68, 32768
    s_nop 0
    buffer_load_dwordx4 v2, s[32:35], s66 offen offset:0 lds
    buffer_load_dwordx4 v3, s[32:35], s66 offen offset:1024 lds
    buffer_load_dwordx4 v4, s[32:35], s66 offen offset:2048 lds
    buffer_load_dwordx4 v5, s[32:35], s66 offen offset:3072 lds
    s_add_u32 m0, s68, 49152
    s_nop 0
    buffer_load_dwordx4 v6, s[36:39], s67 offen offset:0 lds
    buffer_load_dwordx4 v7, s[36:39], s67 offen offset:1024 lds
    buffer_load_dwordx4 v8, s[36:39], s67 offen offset:2048 lds
    buffer_load_dwordx4 v9, s[36:39], s67 offen offset:3072 lds
    s_add_u32 s66, s66, 128
    s_add_u32 s67, s67, 221184
    s_waitcnt vmcnt(9)
    s_barrier
    s_add_u32 m0, s68, 65536
    s_nop 0
    buffer_load_dwordx4 v2, s[32:35], s66 offen offset:0 lds
    buffer_load_dwordx4 v3, s[32:35], s66 offen offset:1024 lds
    buffer_load_dwordx4 v4, s[32:35], s66 offen offset:2048 lds
    buffer_load_dwordx4 v5, s[32:35], s66 offen offset:3072 lds
    s_add_u32 m0, s68, 81920
    s_nop 0
    buffer_load_dwordx4 v6, s[36:39], s67 offen offset:0 lds
    buffer_load_dwordx4 v7, s[36:39], s67 offen offset:1024 lds
    buffer_load_dwordx4 v8, s[36:39], s67 offen offset:2048 lds
    buffer_load_dwordx4 v9, s[36:39], s67 offen offset:3072 lds
    s_add_u32 s66, s66, 128
    s_add_u32 s67, s67, 221184
    ds_read_b64_tr_b16 v[32:33], v23 offset:0
    ds_read_b64_tr_b16 v[34:35], v23 offset:1024
    ds_read_b64_tr_b16 v[36:37], v23 offset:4096
    ds_read_b64_tr_b16 v[38:39], v23 offset:5120
    ds_read_b64_tr_b16 v[40:41], v23 offset:8192
    ds_read_b64_tr_b16 v[42:43], v23 offset:9216
    s_waitcnt vmcnt(16)
    v_readfirstlane_b32 s27, v14
    s_nop 0
    s_cmp_lg_u32 s27, 0
    s_cbranch_scc1 Lnok_14
    s_mov_b32 s30, 0
Lnlp_15:
    s_add_u32 s30, s30, 1
    s_cmp_lg_u32 s30, 200
    s_cbranch_scc1 Lnsk_16
    s_memrealtime s[58:59]
    s_waitcnt lgkmcnt(0)
    s_or_b32 s31, s58, 1
    v_mov_b32 v16, s31
    v_mov_b32 v17, 0
    buffer_atomic_cmpswap v[16:17], v15, s[40:43], 0 offen sc1
Lnsk_16:
    buffer_load_dword v14, v15, s[40:43], 0 offen sc1
    s_waitcnt vmcnt(0)
    v_readfirstlane_b32 s27, v14
    s_nop 0
    s_cmp_lg_u32 s27, 0
    s_cbranch_scc1 Lnok_14
    s_cmp_lt_u32 s30, 40000
    s_cbranch_scc1 Lnlp_15
Lnok_14:
    v_lshlrev_b32 v18, 4, v0
    v_mov_b32 v20, 157584
    v_mov_b32 v21, s27
    ds_write_b32 v20, v21
    s_waitcnt lgkmcnt(0)
    v_mfma_f32_32x32x16_bf16 v[48:63], v[28:31], v[32:35], 0
    v_mfma_f32_32x32x16_bf16 v[48:63], v[28:31], v[36:39], v[48:63]
    v_mfma_f32_32x32x16_bf16 v[48:63], v[44:47], v[40:43], v[48:63]
    v_mov_b32 v161, s27
    v_mov_b32 v163, s27
    s_mov_b64 exec, 3
    buffer_store_dwordx4 v[160:163], v157, s[48:51], s73 offen sc1
    s_mov_b64 exec, -1
    v_mov_b32 v21, s27
    s_nop 5
    v_mov_b32 v20, v48
    s_mov_b32 exec_hi, 0
    buffer_store_dwordx2 v[20:21], v18, s[48:51], s76 offen sc1
    s_mov_b64 exec, -1
    s_cmp_eq_u32 s26, 0
    s_cselect_b32 s74, s74, 2146435072
    v_mov_b32 v20, s27
    v_mov_b32 v21, 0
    s_mov_b64 exec, 1
    buffer_store_dword v20, v21, s[48:51], s74 offen sc1
    s_mov_b64 exec, -1
    s_barrier
    s_add_u32 m0, s68, 98304
    s_nop 0
    buffer_load_dwordx4 v2, s[32:35], s66 offen offset:0 lds
    buffer_load_dwordx4 v3, s[32:35], s66 offen offset:1024 lds
    buffer_load_dwordx4 v4, s[32:35], s66 offen offset:2048 lds
    buffer_load_dwordx4 v5, s[32:35], s66 offen offset:3072 lds
    s_add_u32 m0, s68, 114688
    s_nop 0
    buffer_load_dwordx4 v6, s[36:39], s67 offen offset:0 lds
    buffer_load_dwordx4 v7, s[36:39], s67 offen offset:1024 lds
    buffer_load_dwordx4 v8, s[36:39], s67 offen offset:2048 lds
    buffer_load_dwordx4 v9, s[36:39], s67 offen offset:3072 lds
    s_add_u32 s66, s66, 128
    s_add_u32 s67, s67, 221184
    s_waitcnt vmcnt(19)
    s_barrier
    s_add_u32 m0, s68, 0
    s_nop 0
    buffer_load_dwordx4 v2, s[32:35], s66 offen offset:0 lds
    buffer_load_dwordx4 v3, s[32:35], s66 offen offset:1024 lds
    buffer_load_dwordx4 v4, s[32:35], s66 offen offset:2048 lds
    buffer_load_dwordx4 v5, s[32:35], s66 offen offset:3072 lds
    s_add_u32 m0, s68, 16384
    s_nop 0
    buffer_load_dwordx4 v6, s[36:39], s67 offen offset:0 lds
    buffer_load_dwordx4 v7, s[36:39], s67 offen offset:1024 lds
    buffer_load_dwordx4 v8, s[36:39], s67 offen offset:2048 lds
    buffer_load_dwordx4 v9, s[36:39], s67 offen offset:3072 lds
    s_add_u32 s66, s66, 128
    s_add_u32 s67, s67, 221184
    s_waitcnt vmcnt(19)
    s_barrier
    s_add_u32 m0, s68, 32768
    s_nop 0
    buffer_load_dwordx4 v2, s[32:35], s66 offen offset:0 lds
    buffer_load_dwordx4 v3, s[32:35], s66 offen offset:1024 lds
    buffer_load_dwordx4 v4, s[32:35], s66 offen offset:2048 lds
    buffer_load_dwordx4 v5, s[32:35], s66 offen offset:3072 lds
    s_add_u32 m0, s68, 49152
    s_nop 0
    buffer_load_dwordx4 v6, s[36:39], s67 offen offset:0 lds
    buffer_load_dwordx4 v7, s[36:39], s67 offen offset:1024 lds
    buffer_load_dwordx4 v8, s[36:39], s67 offen offset:2048 lds
    buffer_load_dwordx4 v9, s[36:39], s67 offen offset:3072 lds
    s_add_u32 s66, s66, 128
    s_add_u32 s67, s67, 221184
    s_and_b32 s58, s26, 1
    s_lshl_b32 s58, s58, 6
    v_add_u32 v12, s58, v0
    v_lshlrev_b32 v13, 4, v12
    v_lshlrev_b32 v15, 1, v12
    s_lshl_b32 s72, s62, 11
    s_lshl_b32 s73, s63, 11
    s_add_u32 s73, s73, 65536
    s_lshl_b32 s74, s63, 8
    s_mov_b32 s40, s14
    s_mov_b32 s41, s15
    s_mov_b32 s42, 3456
    s_mov_b32 s43, 0x00020000
    s_cmp_ge_u32 s26, 2
    s_cbranch_scc1 Laugw
    buffer_load_dwordx4 v[56:59], v13, s[48:51], s72 offen sc1
    s_waitcnt vmcnt(1)
    s_barrier
    s_waitcnt vmcnt(0)
    s_mov_b32 s30, 0
Laugx:
    v_cmp_eq_u32 vcc, s27, v57
    v_cmp_eq_u32 s[58:59], s27, v59
    s_nop 0
    s_and_b64 vcc, vcc, s[58:59]
    s_cmp_eq_u64 vcc, -1
    s_cbranch_scc1 Laugx_ok
    s_add_u32 s30, s30, 1
    s_cmp_ge_u32 s30, 40000
    s_cbranch_scc1 Laugx_ok
    buffer_load_dwordx4 v[56:59], v13, s[48:51], s72 offen sc1
    s_waitcnt vmcnt(0)
    s_branch Laugx
Laugx_ok:
    v_rcp_f32 v18, v58
    v_cvt_pk_bf16_f32 v32, -v56, -v56
    v_and_b32 v19, 0xffff0000, v32
    v_sub_f32_e64 v19, -v56, v19
    v_cvt_pk_bf16_f32 v33, v19, v18
    v_and_b32 v19, 0xffff0000, v33
    v_sub_f32 v19, v18, v19
    v_mov_b32 v35, 0
    v_cvt_pk_bf16_f32 v34, v19, v35
    v_add_u32 v13, 152704, v13
    ds_write_b128 v13, v[32:35]
    v_lshlrev_b32 v13, 2, v12
    v_add_u32 v13, 156800, v13
    ds_write_b32 v13, v58
    v_mov_b32 v36, 0
    v_mov_b32 v37, 0
    v_mov_b32 v38, 0
    v_mov_b32 v39, 0
    v_mov_b32 v13, 157312
    ds_write_b128 v13, v[36:39]
    s_branch Laugd
Laugw:
    buffer_load_ushort v62, v15, s[40:43], s74 offen
    s_mov_b32 s59, s73
    buffer_load_dwordx4 v[128:131], v13, s[48:51], s59 offen sc1
    s_add_u32 s59, s59, 28672
    buffer_load_dwordx4 v[132:135], v13, s[48:51], s59 offen sc1
    s_add_u32 s59, s59, 28672
    buffer_load_dwordx4 v[136:139], v13, s[48:51], s59 offen sc1
    s_add_u32 s59, s59, 28672
    buffer_load_dwordx4 v[140:143], v13, s[48:51], s59 offen sc1
    s_add_u32 s59, s59, 28672
    buffer_load_dwordx4 v[144:147], v13, s[48:51], s59 offen sc1
    s_add_u32 s59, s59, 28672
    buffer_load_dwordx4 v[148:151], v13, s[48:51], s59 offen sc1
    s_add_u32 s59, s59, 28672
    buffer_load_dwordx4 v[152:155], v13, s[48:51], s59 offen sc1
    s_add_u32 s59, s59, 28672
    buffer_load_dwordx4 v[156:159], v13, s[48:51], s59 offen sc1
    s_add_u32 s59, s59, 28672
    s_waitcnt vmcnt(9)
    s_barrier
    s_and_b32 s65, s26, 1
    s_mul_i32 s58, s60, 6
    s_add_u32 s59, s58, 5
    s_lshr_b32 s58, s58, 4
    s_lshr_b32 s59, s59, 4
    s_add_u32 s59, s59, 1
    s_mul_i32 s58, s58, 737280
    s_mul_i32 s59, s59, 737280
    s_mov_b32 s32, s16
    s_mov_b32 s33, s17
    s_mov_b32 s34, s59
    s_mov_b32 s35, 0x00020000
    v_lshlrev_b32 v18, 7, v0
    s_lshl_b32 s30, s61, 1
    s_add_u32 s30, s30, s65
    s_lshl_b32 s30, s30, 13
    s_add_u32 s58, s58, s30
    buffer_load_dword v1, v18, s[32:35], s58 offen
    s_add_u32 s58, s58, 524288
    buffer_load_dword v1, v18, s[32:35], s58 offen
    s_add_u32 s58, s58, 524288
    buffer_load_dword v1, v18, s[32:35], s58 offen
    s_add_u32 s58, s58, 524288
    s_waitcnt vmcnt(3)
    s_mov_b32 s30, 0
Laugw_l:
    v_xor_b32 v18, s27, v129
    v_xor_b32 v19, s27, v131
    v_or_b32 v18, v18, v19
    v_xor_b32 v19, s27, v133
    v_or_b32 v18, v18, v19
    v_xor_b32 v19, s27, v135
    v_or_b32 v18, v18, v19
    v_xor_b32 v19, s27, v137
    v_or_b32 v18, v18, v19
    v_xor_b32 v19, s27, v139
    v_or_b32 v18, v18, v19
    v_xor_b32 v19, s27, v141
    v_or_b32 v18, v18, v19
    v_xor_b32 v19, s27, v143
    v_or_b32 v18, v18, v19
    v_xor_b32 v19, s27, v145
    v_or_b32 v18, v18, v19
    v_xor_b32 v19, s27, v147
    v_or_b32 v18, v18, v19
    v_xor_b32 v19, s27, v149
    v_or_b32 v18, v18, v19
    v_xor_b32 v19, s27, v151
    v_or_b32 v18, v18, v19
    v_xor_b32 v19, s27, v153
    v_or_b32 v18, v18, v19
    v_xor_b32 v19, s27, v155
    v_or_b32 v18, v18, v19
    v_xor_b32 v19, s27, v157
    v_or_b32 v18, v18, v19
    v_xor_b32 v19, s27, v159
    v_or_b32 v18, v18, v19
    v_cmp_eq_u32 vcc, 0, v18
    s_nop 0
    s_cmp_eq_u64 vcc, -1
    s_cbranch_scc1 Laugw_ok
    s_add_u32 s30, s30, 1
    s_cmp_ge_u32 s30, 40000
    s_cbranch_scc1 Laugw_ok
    s_mov_b32 s59, s73
    buffer_load_dwordx4 v[128:131], v13, s[48:51], s59 offen sc1
    s_add_u32 s59, s59, 28672
    buffer_load_dwordx4 v[132:135], v13, s[48:51], s59 offen sc1
    s_add_u32 s59, s59, 28672
    buffer_load_dwordx4 v[136:139], v13, s[48:51], s59 offen sc1
    s_add_u32 s59, s59, 28672
    buffer_load_dwordx4 v[140:143], v13, s[48:51], s59 offen sc1
    s_add_u32 s59, s59, 28672
    buffer_load_dwordx4 v[144:147], v13, s[48:51], s59 offen sc1
    s_add_u32 s59, s59, 28672
    buffer_load_dwordx4 v[148:151], v13, s[48:51], s59 offen sc1
    s_add_u32 s59, s59, 28672
    buffer_load_dwordx4 v[152:155], v13, s[48:51], s59 offen sc1
    s_add_u32 s59, s59, 28672
    buffer_load_dwordx4 v[156:159], v13, s[48:51], s59 offen sc1
    s_add_u32 s59, s59, 28672
    s_waitcnt vmcnt(0)
    s_branch Laugw_l
Laugw_ok:
    v_add_f32 v60, v128, v130
    v_add_f32 v60, v60, v132
    v_add_f32 v60, v60, v134
    v_add_f32 v60, v60, v136
    v_add_f32 v60, v60, v138
    v_add_f32 v60, v60, v140
    v_add_f32 v60, v60, v142
    v_add_f32 v60, v60, v144
    v_add_f32 v60, v60, v146
    v_add_f32 v60, v60, v148
    v_add_f32 v60, v60, v150
    v_add_f32 v60, v60, v152
    v_add_f32 v60, v60, v154
    v_add_f32 v60, v60, v156
    v_add_f32 v60, v60, v158
    v_cvt_pk_bf16_f32 v33, v60, v60
    v_and_b32 v19, 0xffff0000, v33
    v_sub_f32 v18, v60, v19
    v_cvt_pk_bf16_f32 v32, v19, v18
    v_and_b32 v33, 0xffff, v33
    v_lshl_or_b32 v33, v62, 16, v33
    v_mov_b32 v34, v62
    v_mov_b32 v35, 0
    v_add_u32 v13, 154752, v13
    ds_write_b128 v13, v[32:35]
Laugd:
    s_waitcnt lgkmcnt(0)
    s_lshl_b32 s58, s26, 2
    s_add_u32 s58, s58, 157344
    v_mov_b32 v18, s58
    v_mov_b32 v19, 1
    ds_write_b32 v18, v19
Ll2:
    s_mul_i32 s65, s61, 52
    s_lshr_b32 s65, s65, 8
    s_mul_i32 s58, s65, 5
    s_sub_u32 s63, s61, s58
    s_mul_i32 s58, s60, 6
    s_add_u32 s58, s58, s65
    s_lshr_b32 s64, s58, 4
    s_and_b32 s62, s58, 15
    s_lshl_b32 s78, s60, 5
    s_add_u32 s78, s78, s61
    s_lshl_b32 s79, s78, 2
    s_add_u32 s79, s79, s26
    s_add_u32 s80, s79, 0
    s_mul_i32 s80, s80, 1280
    s_mul_i32 s81, s26, 2880
    s_add_u32 s81, s81, 65536
    s_add_u32 s58, s61, 4
    s_and_b32 s58, s58, 31
    s_lshr_b32 s59, s58, 1
    s_lshl_b32 s59, s59, 3
    s_add_u32 s59, s59, s60
    s_lshl_b32 s59, s59, 1
    s_and_b32 s58, s58, 1
    s_add_u32 s69, s59, s58
    v_lshlrev_b32 v3, 4, v0
    v_lshrrev_b32 v20, 4, v0
    v_bfe_u32 v21, v0, 2, 2
    v_xor_b32 v21, v21, v20
    v_lshlrev_b32 v21, 2, v21
    v_and_b32 v22, 3, v0
    v_add_u32 v21, v21, v22
    v_lshlrev_b32 v21, 4, v21
    v_mul_u32_u24 v20, 1280, v20
    v_add_u32 v6, v20, v21
    v_add_u32 v7, 4096, v6
    v_add_u32 v8, 8192, v6
    v_add_u32 v9, 12288, v6
    s_lshl_b32 s66, s62, 2
    s_add_u32 s66, s66, s26
    s_mul_i32 s66, s66, 108
    s_mul_i32 s58, s64, 36
    s_add_u32 s66, s66, s58
    s_lshl_b32 s66, s66, 10
    s_mul_i32 s67, s64, 576
    s_lshl_b32 s58, s26, 4
    s_add_u32 s67, s67, s58
    s_mul_i32 s67, s67, 1280
    s_lshl_b32 s58, s63, 8
    s_add_u32 s67, s67, s58
    s_lshl_b32 s68, s26, 12
    s_add_u32 s72, s68, 16384
    s_add_u32 s75, s67, 0
    s_add_u32 s73, s68, 49152
    s_add_u32 s76, s67, 81920
    s_add_u32 s74, s68, 114688
    s_add_u32 s77, s67, 245760
    s_cmp_lt_u32 s61, 30
    s_cselect_b32 s58, 7077888, 0
    s_cselect_b32 s59, 2211840, 0
    s_add_u32 s36, s24, 10485760
    s_addc_u32 s37, s25, 0
    s_mov_b32 s38, s58
    s_mov_b32 s39, 0x00020000
    s_mov_b32 s40, s16
    s_mov_b32 s41, s17
    s_mov_b32 s42, s59
    s_mov_b32 s43, 0x00020000
    s_mov_b32 s48, s24
    s_mov_b32 s49, s25
    s_mov_b32 s50, 33554432
    s_mov_b32 s51, 0x00020000
    s_cmp_le_u32 s69, 161
    s_cselect_b32 s58, 0x1000000, 0
    s_mov_b32 s32, s24
    s_mov_b32 s33, s25
    s_mov_b32 s34, s58
    s_mov_b32 s35, 0x00020000
    v_lshrrev_b32 v20, 2, v0
    v_mul_u32_u24 v12, 82944, v20
    v_bfe_u32 v21, v0, 3, 2
    v_and_b32 v22, 3, v0
    v_xor_b32 v21, v21, v22
    v_lshl_add_u32 v12, v21, 4, v12
    s_add_u32 s58, s68, 131072
    v_add_u32 v15, s58, v3
    s_mul_i32 s71, s26, 20736
    s_lshl_b32 s58, s69, 6
    s_add_u32 s71, s71, s58
    s_add_u32 s71, s71, 7340032
    s_mul_i32 s70, s26, 168
    s_add_u32 s70, s70, s69
    s_lshl_b32 s70, s70, 4
    s_add_u32 s70, s70, 524288
    s_cmp_gt_u32 s69, 161
    s_cbranch_scc1 Lnou
    v_lshrrev_b32 v20, 3, v0
    v_mul_u32_u24 v10, 20736, v20
    v_lshrrev_b32 v21, 4, v0
    v_and_b32 v22, 7, v0
    v_xor_b32 v21, v21, v22
    v_lshl_add_u32 v10, v21, 4, v10
    v_bfe_u32 v20, v0, 2, 2
    v_xor_b32 v20, s26, v20
    v_lshlrev_b32 v20, 4, v20
    v_lshl_add_u32 v13, v0, 6, v20
    v_add_u32 v13, 65536, v13
    v_bfe_u32 v20, v0, 1, 2
    v_xor_b32 v20, s26, v20
    v_lshlrev_b32 v20, 4, v20
    v_lshl_add_u32 v14, v0, 6, v20
    v_add_u32 v14, 131072, v14
    v_min_u32 v16, 31, v0
    v_lshlrev_b32 v16, 4, v16
    v_add_u32 v16, 4096, v16
    s_mul_i32 s82, s26, 663552
    s_lshl_b32 s58, s69, 7
    s_add_u32 s82, s82, s58
    s_add_u32 s83, s82, 4194304
    s_add_u32 s82, s82, 1048576
    s_mov_b32 s31, 720896
    s_cmp_lg_u32 s26, 0
    s_cbranch_scc1 Lpo_17_w
    s_mov_b32 s30, 0
Lpo_17:
    buffer_load_dword v20, v3, s[48:51], s31 offen offset:0 sc1
    buffer_load_dword v21, v3, s[48:51], s31 offen offset:1024 sc1
    buffer_load_dword v22, v3, s[48:51], s31 offen offset:2048 sc1
    buffer_load_dword v23, v3, s[48:51], s31 offen offset:3072 sc1
    buffer_load_dword v24, v16, s[48:51], s31 offen offset:0 sc1
    s_waitcnt vmcnt(0)
    v_xor_b32 v20, s27, v20
    v_xor_b32 v21, s27, v21
    v_or_b32 v20, v20, v21
    v_xor_b32 v22, s27, v22
    v_or_b32 v20, v20, v22
    v_xor_b32 v23, s27, v23
    v_or_b32 v20, v20, v23
    v_xor_b32 v24, s27, v24
    v_or_b32 v20, v20, v24
    v_cmp_eq_u32 vcc, 0, v20
    s_nop 0
    s_cmp_eq_u64 vcc, -1
    s_cbranch_scc1 Lpo_17_ok
    s_add_u32 s30, s30, 1
    s_cmp_ge_u32 s30, 40000
    s_cbranch_scc1 Lpo_17_ok
    s_sleep 4
    s_branch Lpo_17
Lpo_17_ok:
    v_mov_b32 v24, 157456
    v_mov_b32 v20, 1
    v_mov_b32 v21, 1
    v_mov_b32 v22, 1
    v_mov_b32 v23, 1
    ds_write_b128 v24, v[20:23]
Lpo_17_w:
    v_mov_b32 v24, 157456
    s_mov_b32 s30, 0
Lfw_18:
    ds_read_b128 v[20:23], v24
    s_waitcnt lgkmcnt(0)
    v_and_b32 v20, v20, v21
    v_and_b32 v22, v22, v23
    v_and_b32 v20, v20, v22
    s_nop 0
    v_readfirstlane_b32 s58, v20
    s_add_u32 s30, s30, 1
    s_cmp_ge_u32 s30, 320000
    s_cselect_b32 s58, 1, s58
    s_cmp_eq_u32 s58, 0
    s_cbranch_scc1 Lfw_18
    s_add_u32 m0, s68, 65536
    s_nop 0
    buffer_load_dwordx4 v10, s[48:51], s82 offen sc1 lds
    s_add_u32 s82, s82, 165888
    s_add_u32 m0, s68, 66560
    s_nop 0
    buffer_load_dwordx4 v10, s[48:51], s82 offen sc1 lds
    s_add_u32 s82, s82, 165888
    s_add_u32 m0, s68, 67584
    s_nop 0
    buffer_load_dwordx4 v10, s[48:51], s82 offen sc1 lds
    s_add_u32 s82, s82, 165888
    s_add_u32 m0, s68, 68608
    s_nop 0
    buffer_load_dwordx4 v10, s[48:51], s82 offen sc1 lds
    s_add_u32 s82, s82, 165888
    s_add_u32 m0, s68, 81920
    s_nop 0
    buffer_load_dwordx4 v10, s[48:51], s83 offen sc1 lds
    s_add_u32 s83, s83, 165888
    s_add_u32 m0, s68, 82944
    s_nop 0
    buffer_load_dwordx4 v10, s[48:51], s83 offen sc1 lds
    s_add_u32 s83, s83, 165888
    s_add_u32 m0, s68, 83968
    s_nop 0
    buffer_load_dwordx4 v10, s[48:51], s83 offen sc1 lds
    s_add_u32 s83, s83, 165888
    s_add_u32 m0, s68, 84992
    s_nop 0
    buffer_load_dwordx4 v10, s[48:51], s83 offen sc1 lds
    s_add_u32 s83, s83, 165888
    s_mov_b32 s44, s4
    s_mov_b32 s45, s5
    s_mov_b32 s46, 2621440
    s_mov_b32 s47, 0x00020000
    buffer_load_dwordx4 v[160:163], v3, s[44:47], s80 offen
    s_mov_b64 exec, 0xffff
    buffer_load_dwordx4 v[164:167], v3, s[44:47], s80 offen offset:1024
    s_mov_b64 exec, -1
    s_waitcnt vmcnt(2)
    s_lshl_b32 s58, s26, 2
    s_add_u32 s58, s58, 157472
    v_mov_b32 v20, s58
    v_mov_b32 v21, 1
    ds_write_b32 v20, v21
    v_mov_b32 v24, 157472
    s_mov_b32 s30, 0
Lfw_19:
    ds_read_b128 v[20:23], v24
    s_waitcnt lgkmcnt(0)
    v_and_b32 v20, v20, v21
    v_and_b32 v22, v22, v23
    v_and_b32 v20, v20, v22
    s_nop 0
    v_readfirstlane_b32 s58, v20
    s_add_u32 s30, s30, 1
    s_cmp_ge_u32 s30, 320000
    s_cselect_b32 s58, 1, s58
    s_cmp_eq_u32 s58, 0
    s_cbranch_scc1 Lfw_19
    s_setprio 0
    ds_read_b128 v[32:35], v13 offset:0
    ds_read_b128 v[36:39], v13 offset:4096
    ds_read_b128 v[40:43], v13 offset:8192
    ds_read_b128 v[44:47], v13 offset:12288
    ds_read_b128 v[48:51], v13 offset:16384
    ds_read_b128 v[52:55], v13 offset:20480
    ds_read_b128 v[56:59], v13 offset:24576
    ds_read_b128 v[60:63], v13 offset:28672
    s_waitcnt lgkmcnt(4)
    v_mfma_f32_32x32x16_bf16 v[128:143], v[32:35], v[64:67], 0
    v_mfma_f32_32x32x16_bf16 v[144:159], v[32:35], v[80:83], 0
    v_mfma_f32_32x32x16_bf16 v[128:143], v[36:39], v[68:71], v[128:143]
    v_mfma_f32_32x32x16_bf16 v[144:159], v[36:39], v[84:87], v[144:159]
    v_mfma_f32_32x32x16_bf16 v[128:143], v[40:43], v[72:75], v[128:143]
    v_mfma_f32_32x32x16_bf16 v[144:159], v[40:43], v[88:91], v[144:159]
    v_mfma_f32_32x32x16_bf16 v[128:143], v[44:47], v[76:79], v[128:143]
    v_mfma_f32_32x32x16_bf16 v[144:159], v[44:47], v[92:95], v[144:159]
    v_mov_b32 v24, 157440
    s_mov_b32 s30, 0
Lfw_20:
    ds_read_b128 v[20:23], v24
    s_waitcnt lgkmcnt(0)
    v_and_b32 v20, v20, v21
    v_and_b32 v22, v22, v23
    v_and_b32 v20, v20, v22
    s_nop 0
    v_readfirstlane_b32 s58, v20
    s_add_u32 s30, s30, 1
    s_cmp_ge_u32 s30, 320000
    s_cselect_b32 s58, 1, s58
    s_cmp_eq_u32 s58, 0
    s_cbranch_scc1 Lfw_20
    v_mul_f32 v16, v128, v96
    v_mul_f32 v17, v144, v96
    v_fmac_f32 v16, v144, v112
    v_fma_f32 v17, -v128, v112, v17
    v_cvt_pk_bf16_f32 v32, v16, v17
    v_mul_f32 v18, v129, v97
    v_mul_f32 v19, v145, v97
    v_fmac_f32 v18, v145, v113
    v_fma_f32 v19, -v129, v113, v19
    v_cvt_pk_bf16_f32 v33, v18, v19
    v_mul_f32 v16, v130, v98
    v_mul_f32 v17, v146, v98
    v_fmac_f32 v16, v146, v114
    v_fma_f32 v17, -v130, v114, v17
    v_cvt_pk_bf16_f32 v34, v16, v17
    v_mul_f32 v18, v131, v99
    v_mul_f32 v19, v147, v99
    v_fmac_f32 v18, v147, v115
    v_fma_f32 v19, -v131, v115, v19
    v_cvt_pk_bf16_f32 v35, v18, v19
    v_mul_f32 v16, v132, v100
    v_mul_f32 v17, v148, v100
    s_mov_b32 m0, s72
    s_nop 0
    buffer_load_dwordx4 v6, s[40:43], s75 offen offset:0 lds
    v_fmac_f32 v16, v148, v116
    v_fma_f32 v17, -v132, v116, v17
    v_cvt_pk_bf16_f32 v36, v16, v17
    v_mul_f32 v18, v133, v101
    v_mul_f32 v19, v149, v101
    v_fmac_f32 v18, v149, v117
    v_fma_f32 v19, -v133, v117, v19
    v_cvt_pk_bf16_f32 v37, v18, v19
    v_mul_f32 v16, v134, v102
    v_mul_f32 v17, v150, v102
    v_fmac_f32 v16, v150, v118
    v_fma_f32 v17, -v134, v118, v17
    v_cvt_pk_bf16_f32 v38, v16, v17
    v_mul_f32 v18, v135, v103
    v_mul_f32 v19, v151, v103
    v_fmac_f32 v18, v151, v119
    v_fma_f32 v19, -v135, v119, v19
    v_cvt_pk_bf16_f32 v39, v18, v19
    v_mul_f32 v16, v136, v104
    v_mul_f32 v17, v152, v104
    v_fmac_f32 v16, v152, v120
    v_fma_f32 v17, -v136, v120, v17
    s_mov_b32 m0, s72
    s_nop 0
    buffer_load_dwordx4 v7, s[40:43], s75 offen offset:1024 lds
    v_cvt_pk_bf16_f32 v40, v16, v17
    v_mul_f32 v18, v137, v105
    v_mul_f32 v19, v153, v105
    v_fmac_f32 v18, v153, v121
    v_fma_f32 v19, -v137, v121, v19
    v_cvt_pk_bf16_f32 v41, v18, v19
    v_mul_f32 v16, v138, v106
    v_mul_f32 v17, v154, v106
    v_fmac_f32 v16, v154, v122
    v_fma_f32 v17, -v138, v122, v17
    v_cvt_pk_bf16_f32 v42, v16, v17
    v_mul_f32 v18, v139, v107
    v_mul_f32 v19, v155, v107
    v_fmac_f32 v18, v155, v123
    v_fma_f32 v19, -v139, v123, v19
    v_cvt_pk_bf16_f32 v43, v18, v19
    v_mul_f32 v16, v140, v108
    v_mul_f32 v17, v156, v108
    v_fmac_f32 v16, v156, v124
    v_fma_f32 v17, -v140, v124, v17
    v_cvt_pk_bf16_f32 v44, v16, v17
    v_mul_f32 v18, v141, v109
    s_mov_b32 m0, s72
    s_nop 0
    buffer_load_dwordx4 v8, s[40:43], s75 offen offset:2048 lds
    v_mul_f32 v19, v157, v109
    v_fmac_f32 v18, v157, v125
    v_fma_f32 v19, -v141, v125, v19
    v_cvt_pk_bf16_f32 v45, v18, v19
    v_mul_f32 v16, v142, v110
    v_mul_f32 v17, v158, v110
    v_fmac_f32 v16, v158, v126
    v_fma_f32 v17, -v142, v126, v17
    v_cvt_pk_bf16_f32 v46, v16, v17
    v_mul_f32 v18, v143, v111
    v_mul_f32 v19, v159, v111
    v_fmac_f32 v18, v159, v127
    v_fma_f32 v19, -v143, v127, v19
    v_cvt_pk_bf16_f32 v47, v18, v19
    v_mfma_f32_32x32x16_bf16 v[128:143], v[64:67], v[32:35], 0
    s_mov_b32 m0, s72
    s_nop 0
    buffer_load_dwordx4 v9, s[40:43], s75 offen offset:3072 lds
    v_mfma_f32_32x32x16_bf16 v[144:159], v[80:83], v[32:35], 0
    v_mfma_f32_32x32x16_bf16 v[128:143], v[68:71], v[36:39], v[128:143]
    v_mfma_f32_32x32x16_bf16 v[144:159], v[84:87], v[36:39], v[144:159]
    s_mov_b32 m0, s73
    s_nop 0
    buffer_load_dwordx4 v6, s[40:43], s76 offen offset:0 lds
    v_mfma_f32_32x32x16_bf16 v[128:143], v[72:75], v[40:43], v[128:143]
    v_mfma_f32_32x32x16_bf16 v[144:159], v[88:91], v[40:43], v[144:159]
    v_mfma_f32_32x32x16_bf16 v[128:143], v[76:79], v[44:47], v[128:143]
    s_mov_b32 m0, s73
    s_nop 0
    buffer_load_dwordx4 v7, s[40:43], s76 offen offset:1024 lds
    v_mfma_f32_32x32x16_bf16 v[144:159], v[92:95], v[44:47], v[144:159]
    v_lshlrev_b32 v18, 16, v48
    v_and_b32 v19, 0xffff0000, v48
    s_nop 5
    v_mul_f32 v16, v128, v18
    v_mul_f32 v17, v128, v19
    s_nop 1
    v_fma_f32 v16, -v144, v19, v16
    v_fma_f32 v17, -v144, v18, -v17
    v_cvt_pk_bf16_f32 v32, v16, v17
    v_lshlrev_b32 v22, 16, v49
    v_and_b32 v23, 0xffff0000, v49
    v_mul_f32 v20, v129, v22
    v_mul_f32 v21, v129, v23
    v_fma_f32 v20, -v145, v23, v20
    v_fma_f32 v21, -v145, v22, -v21
    v_cvt_pk_bf16_f32 v33, v20, v21
    s_mov_b32 m0, s73
    s_nop 0
    buffer_load_dwordx4 v8, s[40:43], s76 offen offset:2048 lds
    v_lshlrev_b32 v18, 16, v50
    v_and_b32 v19, 0xffff0000, v50
    v_mul_f32 v16, v130, v18
    v_mul_f32 v17, v130, v19
    v_fma_f32 v16, -v146, v19, v16
    v_fma_f32 v17, -v146, v18, -v17
    v_cvt_pk_bf16_f32 v34, v16, v17
    v_lshlrev_b32 v22, 16, v51
    v_and_b32 v23, 0xffff0000, v51
    v_mul_f32 v20, v131, v22
    v_mul_f32 v21, v131, v23
    v_fma_f32 v20, -v147, v23, v20
    v_fma_f32 v21, -v147, v22, -v21
    v_cvt_pk_bf16_f32 v35, v20, v21
    v_lshlrev_b32 v18, 16, v52
    v_and_b32 v19, 0xffff0000, v52
    v_mul_f32 v16, v132, v18
    v_mul_f32 v17, v132, v19
    v_fma_f32 v16, -v148, v19, v16
    v_fma_f32 v17, -v148, v18, -v17
    v_cvt_pk_bf16_f32 v36, v16, v17
    v_lshlrev_b32 v22, 16, v53
    s_mov_b32 m0, s73
    s_nop 0
    buffer_load_dwordx4 v9, s[40:43], s76 offen offset:3072 lds
    v_and_b32 v23, 0xffff0000, v53
    v_mul_f32 v20, v133, v22
    v_mul_f32 v21, v133, v23
    v_fma_f32 v20, -v149, v23, v20
    v_fma_f32 v21, -v149, v22, -v21
    v_cvt_pk_bf16_f32 v37, v20, v21
    v_lshlrev_b32 v18, 16, v54
    v_and_b32 v19, 0xffff0000, v54
    v_mul_f32 v16, v134, v18
    v_mul_f32 v17, v134, v19
    v_fma_f32 v16, -v150, v19, v16
    v_fma_f32 v17, -v150, v18, -v17
    v_cvt_pk_bf16_f32 v38, v16, v17
    v_lshlrev_b32 v22, 16, v55
    v_and_b32 v23, 0xffff0000, v55
    v_mul_f32 v20, v135, v22
    v_mul_f32 v21, v135, v23
    v_fma_f32 v20, -v151, v23, v20
    v_fma_f32 v21, -v151, v22, -v21
    v_cvt_pk_bf16_f32 v39, v20, v21
    v_lshlrev_b32 v18, 16, v56
    v_and_b32 v19, 0xffff0000, v56
    s_mov_b32 m0, s74
    s_nop 0
    buffer_load_dwordx4 v6, s[40:43], s77 offen offset:0 lds
    v_mul_f32 v16, v136, v18
    v_mul_f32 v17, v136, v19
    v_fma_f32 v16, -v152, v19, v16
    v_fma_f32 v17, -v152, v18, -v17
    v_cvt_pk_bf16_f32 v40, v16, v17
    v_lshlrev_b32 v22, 16, v57
    v_and_b32 v23, 0xffff0000, v57
    v_mul_f32 v20, v137, v22
    v_mul_f32 v21, v137, v23
    v_fma_f32 v20, -v153, v23, v20
    v_fma_f32 v21, -v153, v22, -v21
    v_cvt_pk_bf16_f32 v41, v20, v21
    v_lshlrev_b32 v18, 16, v58
    v_and_b32 v19, 0xffff0000, v58
    v_mul_f32 v16, v138, v18
    v_mul_f32 v17, v138, v19
    v_fma_f32 v16, -v154, v19, v16
    v_fma_f32 v17, -v154, v18, -v17
    v_cvt_pk_bf16_f32 v42, v16, v17
    v_lshlrev_b32 v22, 16, v59
    v_and_b32 v23, 0xffff0000, v59
    v_mul_f32 v20, v139, v22
    s_mov_b32 m0, s74
    s_nop 0
    buffer_load_dwordx4 v7, s[40:43], s77 offen offset:1024 lds
    v_mul_f32 v21, v139, v23
    v_fma_f32 v20, -v155, v23, v20
    v_fma_f32 v21, -v155, v22, -v21
    v_cvt_pk_bf16_f32 v43, v20, v21
    v_lshlrev_b32 v18, 16, v60
    v_and_b32 v19, 0xffff0000, v60
    v_mul_f32 v16, v140, v18
    v_mul_f32 v17, v140, v19
    v_fma_f32 v16, -v156, v19, v16
    v_fma_f32 v17, -v156, v18, -v17
    v_cvt_pk_bf16_f32 v44, v16, v17
    v_lshlrev_b32 v22, 16, v61
    v_and_b32 v23, 0xffff0000, v61
    v_mul_f32 v20, v141, v22
    v_mul_f32 v21, v141, v23
    v_fma_f32 v20, -v157, v23, v20
    v_fma_f32 v21, -v157, v22, -v21
    v_cvt_pk_bf16_f32 v45, v20, v21
    v_lshlrev_b32 v18, 16, v62
    v_and_b32 v19, 0xffff0000, v62
    v_mul_f32 v16, v142, v18
    v_mul_f32 v17, v142, v19
    s_mov_b32 m0, s74
    s_nop 0
    buffer_load_dwordx4 v8, s[40:43], s77 offen offset:2048 lds
    v_fma_f32 v16, -v158, v19, v16
    v_fma_f32 v17, -v158, v18, -v17
    v_cvt_pk_bf16_f32 v46, v16, v17
    v_lshlrev_b32 v22, 16, v63
    v_and_b32 v23, 0xffff0000, v63
    v_mul_f32 v20, v143, v22
    v_mul_f32 v21, v143, v23
    v_fma_f32 v20, -v159, v23, v20
    v_fma_f32 v21, -v159, v22, -v21
    v_cvt_pk_bf16_f32 v47, v20, v21
    v_mfma_f32_32x32x16_bf16 v[128:143], v[32:35], v[64:67], 0
    v_mfma_f32_32x32x16_bf16 v[144:159], v[32:35], v[80:83], 0
    s_mov_b32 m0, s74
    s_nop 0
    buffer_load_dwordx4 v9, s[40:43], s77 offen offset:3072 lds
    v_mfma_f32_32x32x16_bf16 v[128:143], v[36:39], v[68:71], v[128:143]
    v_mfma_f32_32x32x16_bf16 v[144:159], v[36:39], v[84:87], v[144:159]
    v_mfma_f32_32x32x16_bf16 v[128:143], v[40:43], v[72:75], v[128:143]
    v_mfma_f32_32x32x16_bf16 v[144:159], v[40:43], v[88:91], v[144:159]
    v_mfma_f32_32x32x16_bf16 v[128:143], v[44:47], v[76:79], v[128:143]
    v_mfma_f32_32x32x16_bf16 v[144:159], v[44:47], v[92:95], v[144:159]
    s_nop 10
    v_mul_f32 v16, v128, v96
    v_mul_f32 v17, v144, v96
    v_fmac_f32 v16, v144, v112
    v_fma_f32 v17, -v128, v112, v17
    v_cvt_pk_bf16_f32 v32, v16, v17
    v_mul_f32 v18, v129, v97
    v_mul_f32 v19, v145, v97
    v_fmac_f32 v18, v145, v113
    v_fma_f32 v19, -v129, v113, v19
    v_cvt_pk_bf16_f32 v33, v18, v19
    v_mul_f32 v16, v130, v98
    v_mul_f32 v17, v146, v98
    v_fmac_f32 v16, v146, v114
    v_fma_f32 v17, -v130, v114, v17
    v_cvt_pk_bf16_f32 v34, v16, v17
    v_mul_f32 v18, v131, v99
    v_mul_f32 v19, v147, v99
    v_fmac_f32 v18, v147, v115
    v_fma_f32 v19, -v131, v115, v19
    v_cvt_pk_bf16_f32 v35, v18, v19
    v_mul_f32 v16, v132, v100
    v_mul_f32 v17, v148, v100
    v_fmac_f32 v16, v148, v116
    v_fma_f32 v17, -v132, v116, v17
    v_cvt_pk_bf16_f32 v36, v16, v17
    v_mul_f32 v18, v133, v101
    v_mul_f32 v19, v149, v101
    v_fmac_f32 v18, v149, v117
    v_fma_f32 v19, -v133, v117, v19
    v_cvt_pk_bf16_f32 v37, v18, v19
    v_mul_f32 v16, v134, v102
    v_mul_f32 v17, v150, v102
    v_fmac_f32 v16, v150, v118
    v_fma_f32 v17, -v134, v118, v17
    v_cvt_pk_bf16_f32 v38, v16, v17
    v_mul_f32 v18, v135, v103
    v_mul_f32 v19, v151, v103
    v_fmac_f32 v18, v151, v119
    v_fma_f32 v19, -v135, v119, v19
    v_cvt_pk_bf16_f32 v39, v18, v19
    v_mul_f32 v16, v136, v104
    v_mul_f32 v17, v152, v104
    v_fmac_f32 v16, v152, v120
    v_fma_f32 v17, -v136, v120, v17
    v_cvt_pk_bf16_f32 v40, v16, v17
    v_mul_f32 v18, v137, v105
    v_mul_f32 v19, v153, v105
    v_fmac_f32 v18, v153, v121
    v_fma_f32 v19, -v137, v121, v19
    v_cvt_pk_bf16_f32 v41, v18, v19
    v_mul_f32 v16, v138, v106
    v_mul_f32 v17, v154, v106
    v_fmac_f32 v16, v154, v122
    v_fma_f32 v17, -v138, v122, v17
    v_cvt_pk_bf16_f32 v42, v16, v17
    v_mul_f32 v18, v139, v107
    v_mul_f32 v19, v155, v107
    v_fmac_f32 v18, v155, v123
    v_fma_f32 v19, -v139, v123, v19
    v_cvt_pk_bf16_f32 v43, v18, v19
    v_mul_f32 v16, v140, v108
    v_mul_f32 v17, v156, v108
    v_fmac_f32 v16, v156, v124
    v_fma_f32 v17, -v140, v124, v17
    v_cvt_pk_bf16_f32 v44, v16, v17
    v_mul_f32 v18, v141, v109
    v_mul_f32 v19, v157, v109
    v_fmac_f32 v18, v157, v125
    v_fma_f32 v19, -v141, v125, v19
    v_cvt_pk_bf16_f32 v45, v18, v19
    v_mul_f32 v16, v142, v110
    v_mul_f32 v17, v158, v110
    v_fmac_f32 v16, v158, v126
    v_fma_f32 v17, -v142, v126, v17
    v_cvt_pk_bf16_f32 v46, v16, v17
    v_mul_f32 v18, v143, v111
    v_mul_f32 v19, v159, v111
    v_fmac_f32 v18, v159, v127
    v_fma_f32 v19, -v143, v127, v19
    v_cvt_pk_bf16_f32 v47, v18, v19
    v_mfma_f32_32x32x16_bf16 v[128:143], v[32:35], v[64:67], 0
    v_mfma_f32_32x32x16_bf16 v[144:159], v[32:35], v[80:83], 0
    v_mfma_f32_32x32x16_bf16 v[128:143], v[36:39], v[68:71], v[128:143]
    v_mfma_f32_32x32x16_bf16 v[144:159], v[36:39], v[84:87], v[144:159]
    v_mfma_f32_32x32x16_bf16 v[128:143], v[40:43], v[72:75], v[128:143]
    v_mfma_f32_32x32x16_bf16 v[144:159], v[40:43], v[88:91], v[144:159]
    v_mfma_f32_32x32x16_bf16 v[128:143], v[44:47], v[76:79], v[128:143]
    v_mfma_f32_32x32x16_bf16 v[144:159], v[44:47], v[92:95], v[144:159]
    s_nop 11
    v_cvt_pk_bf16_f32 v48, v128, v144
    v_cvt_pk_bf16_f32 v49, v129, v145
    v_cvt_pk_bf16_f32 v50, v130, v146
    v_cvt_pk_bf16_f32 v51, v131, v147
    ds_write_b128 v14, v[48:51] offset:0
    v_cvt_pk_bf16_f32 v52, v132, v148
    v_cvt_pk_bf16_f32 v53, v133, v149
    v_cvt_pk_bf16_f32 v54, v134, v150
    v_cvt_pk_bf16_f32 v55, v135, v151
    ds_write_b128 v14, v[52:55] offset:4096
    v_cvt_pk_bf16_f32 v56, v136, v152
    v_cvt_pk_bf16_f32 v57, v137, v153
    v_cvt_pk_bf16_f32 v58, v138, v154
    v_cvt_pk_bf16_f32 v59, v139, v155
    ds_write_b128 v14, v[56:59] offset:8192
    v_cvt_pk_bf16_f32 v60, v140, v156
    v_cvt_pk_bf16_f32 v61, v141, v157
    v_cvt_pk_bf16_f32 v62, v142, v158
    v_cvt_pk_bf16_f32 v63, v143, v159
    ds_write_b128 v14, v[60:63] offset:12288
    s_waitcnt lgkmcnt(0)
    s_lshl_b32 s58, s26, 2
    s_add_u32 s58, s58, 157488
    v_mov_b32 v20, s58
    v_mov_b32 v21, 1
    ds_write_b32 v20, v21
    v_mov_b32 v24, 157488
    s_mov_b32 s30, 0
Lfw_21:
    ds_read_b128 v[20:23], v24
    s_waitcnt lgkmcnt(0)
    v_and_b32 v20, v20, v21
    v_and_b32 v22, v22, v23
    v_and_b32 v20, v20, v22
    s_nop 0
    v_readfirstlane_b32 s58, v20
    s_add_u32 s30, s30, 1
    s_cmp_ge_u32 s30, 320000
    s_cselect_b32 s58, 1, s58
    s_cmp_eq_u32 s58, 0
    s_cbranch_scc1 Lfw_21
    s_branch Lu_j
Lnou:
    s_mov_b32 s44, s4
    s_mov_b32 s45, s5
    s_mov_b32 s46, 2621440
    s_mov_b32 s47, 0x00020000
    buffer_load_dwordx4 v[160:163], v3, s[44:47], s80 offen
    s_mov_b64 exec, 0xffff
    buffer_load_dwordx4 v[164:167], v3, s[44:47], s80 offen offset:1024
    s_mov_b64 exec, -1
    v_mov_b32 v24, 157440
    s_mov_b32 s30, 0
Lfw_22:
    ds_read_b128 v[20:23], v24
    s_waitcnt lgkmcnt(0)
    v_and_b32 v20, v20, v21
    v_and_b32 v22, v22, v23
    v_and_b32 v20, v20, v22
    s_nop 0
    v_readfirstlane_b32 s58, v20
    s_add_u32 s30, s30, 1
    s_cmp_ge_u32 s30, 320000
    s_cselect_b32 s58, 1, s58
    s_cmp_eq_u32 s58, 0
    s_cbranch_scc1 Lfw_22
    s_mov_b32 m0, s72
    s_nop 0
    buffer_load_dwordx4 v6, s[40:43], s75 offen offset:0 lds
    s_mov_b32 m0, s72
    s_nop 0
    buffer_load_dwordx4 v7, s[40:43], s75 offen offset:1024 lds
    s_mov_b32 m0, s72
    s_nop 0
    buffer_load_dwordx4 v8, s[40:43], s75 offen offset:2048 lds
    s_mov_b32 m0, s72
    s_nop 0
    buffer_load_dwordx4 v9, s[40:43], s75 offen offset:3072 lds
    s_mov_b32 m0, s73
    s_nop 0
    buffer_load_dwordx4 v6, s[40:43], s76 offen offset:0 lds
    s_mov_b32 m0, s73
    s_nop 0
    buffer_load_dwordx4 v7, s[40:43], s76 offen offset:1024 lds
    s_mov_b32 m0, s73
    s_nop 0
    buffer_load_dwordx4 v8, s[40:43], s76 offen offset:2048 lds
    s_mov_b32 m0, s73
    s_nop 0
    buffer_load_dwordx4 v9, s[40:43], s76 offen offset:3072 lds
    s_mov_b32 m0, s74
    s_nop 0
    buffer_load_dwordx4 v6, s[40:43], s77 offen offset:0 lds
    s_mov_b32 m0, s74
    s_nop 0
    buffer_load_dwordx4 v7, s[40:43], s77 offen offset:1024 lds
    s_mov_b32 m0, s74
    s_nop 0
    buffer_load_dwordx4 v8, s[40:43], s77 offen offset:2048 lds
    s_mov_b32 m0, s74
    s_nop 0
    buffer_load_dwordx4 v9, s[40:43], s77 offen offset:3072 lds
Lu_j:
    s_setprio 2
    ds_read_b128 v[64:67], v15 offset:0
    ds_read_b128 v[68:71], v15 offset:1024
    ds_read_b128 v[72:75], v15 offset:2048
    ds_read_b128 v[76:79], v15 offset:3072
    s_waitcnt lgkmcnt(0)
    s_add_u32 s58, s71, 0
    buffer_store_dwordx4 v[64:67], v12, s[32:35], s58 offen sc1
    s_add_u32 s58, s71, 1327104
    buffer_store_dwordx4 v[68:71], v12, s[32:35], s58 offen sc1
    s_add_u32 s58, s71, 10368
    buffer_store_dwordx4 v[72:75], v12, s[32:35], s58 offen sc1
    s_add_u32 s58, s71, 1337472
    buffer_store_dwordx4 v[76:79], v12, s[32:35], s58 offen sc1
    s_add_u32 m0, s68, 81920
    s_add_u32 s58, s67, 163840
    buffer_load_dwordx4 v6, s[40:43], s58 offen offset:0 lds
    buffer_load_dwordx4 v7, s[40:43], s58 offen offset:1024 lds
    buffer_load_dwordx4 v8, s[40:43], s58 offen offset:2048 lds
    buffer_load_dwordx4 v9, s[40:43], s58 offen offset:3072 lds
    v_mov_b32 v24, 157504
    s_mov_b32 s30, 0
Lfw_23:
    ds_read_b128 v[20:23], v24
    s_waitcnt lgkmcnt(0)
    v_and_b32 v20, v20, v21
    v_and_b32 v22, v22, v23
    v_and_b32 v20, v20, v22
    s_nop 0
    v_readfirstlane_b32 s58, v20
    s_add_u32 s30, s30, 1
    s_cmp_ge_u32 s30, 320000
    s_cselect_b32 s58, 1, s58
    s_cmp_eq_u32 s58, 0
    s_cbranch_scc1 Lfw_23
    s_add_u32 m0, s68, 0
    s_nop 0
    buffer_load_dwordx4 v3, s[36:39], s66 offen offset:0 sc1 lds
    buffer_load_dwordx4 v3, s[36:39], s66 offen offset:1024 sc1 lds
    buffer_load_dwordx4 v3, s[36:39], s66 offen offset:2048 sc1 lds
    buffer_load_dwordx4 v3, s[36:39], s66 offen offset:3072 sc1 lds
    s_add_u32 s66, s66, 4096
    s_add_u32 m0, s68, 32768
    s_nop 0
    buffer_load_dwordx4 v3, s[36:39], s66 offen offset:0 sc1 lds
    buffer_load_dwordx4 v3, s[36:39], s66 offen offset:1024 sc1 lds
    buffer_load_dwordx4 v3, s[36:39], s66 offen offset:2048 sc1 lds
    buffer_load_dwordx4 v3, s[36:39], s66 offen offset:3072 sc1 lds
    s_add_u32 s66, s66, 4096
    s_waitcnt vmcnt(4)
    s_barrier
    s_add_u32 m0, s68, 65536
    s_nop 0
    buffer_load_dwordx4 v3, s[36:39], s66 offen offset:0 sc1 lds
    buffer_load_dwordx4 v3, s[36:39], s66 offen offset:1024 sc1 lds
    buffer_load_dwordx4 v3, s[36:39], s66 offen offset:2048 sc1 lds
    buffer_load_dwordx4 v3, s[36:39], s66 offen offset:3072 sc1 lds
    s_add_u32 s66, s66, 4096
    s_add_u32 m0, s68, 98304
    s_nop 0
    buffer_load_dwordx4 v3, s[36:39], s66 offen offset:0 sc1 lds
    buffer_load_dwordx4 v3, s[36:39], s66 offen offset:1024 sc1 lds
    buffer_load_dwordx4 v3, s[36:39], s66 offen offset:2048 sc1 lds
    buffer_load_dwordx4 v3, s[36:39], s66 offen offset:3072 sc1 lds
    s_add_u32 s66, s66, 4096
    v_mov_b32 v20, s27
    v_mov_b32 v21, 0
    s_mov_b64 exec, 1
    buffer_store_dword v20, v21, s[32:35], s70 offen sc1
    s_mov_b64 exec, -1
    s_waitcnt vmcnt(9)
    s_barrier
    s_add_u32 m0, s68, 0
    s_nop 0
    buffer_load_dwordx4 v3, s[36:39], s66 offen offset:0 sc1 lds
    buffer_load_dwordx4 v3, s[36:39], s66 offen offset:1024 sc1 lds
    buffer_load_dwordx4 v3, s[36:39], s66 offen offset:2048 sc1 lds
    buffer_load_dwordx4 v3, s[36:39], s66 offen offset:3072 sc1 lds
    s_add_u32 s66, s66, 4096
    s_add_u32 m0, s68, 16384
    s_add_u32 s58, s67, 327680
    buffer_load_dwordx4 v6, s[40:43], s58 offen offset:0 lds
    buffer_load_dwordx4 v7, s[40:43], s58 offen offset:1024 lds
    buffer_load_dwordx4 v8, s[40:43], s58 offen offset:2048 lds
    buffer_load_dwordx4 v9, s[40:43], s58 offen offset:3072 lds
    s_waitcnt vmcnt(13)
    s_barrier
    s_add_u32 m0, s68, 32768
    s_nop 0
    buffer_load_dwordx4 v3, s[36:39], s66 offen offset:0 sc1 lds
    buffer_load_dwordx4 v3, s[36:39], s66 offen offset:1024 sc1 lds
    buffer_load_dwordx4 v3, s[36:39], s66 offen offset:2048 sc1 lds
    buffer_load_dwordx4 v3, s[36:39], s66 offen offset:3072 sc1 lds
    s_add_u32 s66, s66, 4096
    s_add_u32 m0, s68, 49152
    s_add_u32 s58, s67, 409600
    buffer_load_dwordx4 v6, s[40:43], s58 offen offset:0 lds
    buffer_load_dwordx4 v7, s[40:43], s58 offen offset:1024 lds
    buffer_load_dwordx4 v8, s[40:43], s58 offen offset:2048 lds
    buffer_load_dwordx4 v9, s[40:43], s58 offen offset:3072 lds
    s_waitcnt vmcnt(17)
    s_barrier
    s_add_u32 m0, s68, 65536
    s_nop 0
    buffer_load_dwordx4 v3, s[36:39], s66 offen offset:0 sc1 lds
    buffer_load_dwordx4 v3, s[36:39], s66 offen offset:1024 sc1 lds
    buffer_load_dwordx4 v3, s[36:39], s66 offen offset:2048 sc1 lds
    buffer_load_dwordx4 v3, s[36:39], s66 offen offset:3072 sc1 lds
    s_add_u32 s66, s66, 4096
    s_add_u32 m0, s68, 81920
    s_add_u32 s58, s67, 491520
    buffer_load_dwordx4 v6, s[40:43], s58 offen offset:0 lds
    buffer_load_dwordx4 v7, s[40:43], s58 offen offset:1024 lds
    buffer_load_dwordx4 v8, s[40:43], s58 offen offset:2048 lds
    buffer_load_dwordx4 v9, s[40:43], s58 offen offset:3072 lds
    v_mov_b32 v32, 0
    v_mov_b32 v33, 0
    v_mov_b32 v34, 0
    v_mov_b32 v35, 0
    v_mov_b32 v36, 0
    v_mov_b32 v37, 0
    v_mov_b32 v38, 0
    v_mov_b32 v39, 0
    v_mov_b32 v40, 0
    v_mov_b32 v41, 0
    v_mov_b32 v42, 0
    v_mov_b32 v43, 0
    v_mov_b32 v44, 0
    v_mov_b32 v45, 0
    v_mov_b32 v46, 0
    v_mov_b32 v47, 0
    v_and_b32 v20, 15, v0
    v_lshrrev_b32 v21, 5, v0
    v_bfe_u32 v22, v0, 4, 1
    v_mul_u32_u24 v23, 80, v21
    v_add_u32 v23, v23, v20
    v_lshlrev_b32 v23, 4, v23
    v_mul_u32_u24 v22, 5184, v22
    s_lshl_b32 s58, s26, 2
    s_add_u32 s58, s58, 32768
    v_add_u32 v22, s58, v22
    v_add_u32 v28, v23, v22
    v_sub_u32 v29, v22, v23
    v_add_u32 v29, 1600, v29
    v_and_b32 v22, 31, v0
    v_cvt_f32_u32 v22, v22
    v_mul_f32 v22, 0x3acccccd, v22
    v_cvt_f32_u32 v23, v21
    v_mul_f32 v23, 4.0, v23
    v_mul_f32 v23, v23, v22
    v_cvt_f32_u32 v24, s79
    v_fmamk_f32 v24, v24, 0x3a000000, v23
    v_fmamk_f32 v112, v22, 0x00000000, v23
    v_fmamk_f32 v113, v22, 0x3f800000, v23
    v_fmamk_f32 v114, v22, 0x40000000, v23
    v_fmamk_f32 v115, v22, 0x40400000, v23
    v_fmamk_f32 v116, v22, 0x41000000, v23
    v_fmamk_f32 v117, v22, 0x41100000, v23
    v_fmamk_f32 v118, v22, 0x41200000, v23
    v_fmamk_f32 v120, v22, 0x00000000, v24
    v_fmamk_f32 v121, v22, 0x3f800000, v24
    v_fmamk_f32 v122, v22, 0x40000000, v24
    v_fmamk_f32 v123, v22, 0x40400000, v24
    v_fmamk_f32 v124, v22, 0x41000000, v24
    v_fmamk_f32 v125, v22, 0x41100000, v24
    v_fmamk_f32 v126, v22, 0x41200000, v24
    v_cos_f32 v96, v112
    v_sin_f32 v112, v112
    v_cos_f32 v97, v113
    v_sin_f32 v113, v113
    v_cos_f32 v98, v114
    v_sin_f32 v114, v114
    v_cos_f32 v99, v115
    v_sin_f32 v115, v115
    v_cos_f32 v100, v116
    v_sin_f32 v116, v116
    v_cos_f32 v101, v117
    v_sin_f32 v117, v117
    v_cos_f32 v102, v118
    v_sin_f32 v118, v118
    v_cos_f32 v104, v120
    v_sin_f32 v120, v120
    v_cos_f32 v105, v121
    v_sin_f32 v121, v121
    v_cos_f32 v106, v122
    v_sin_f32 v122, v122
    v_cos_f32 v107, v123
    v_sin_f32 v123, v123
    v_cos_f32 v108, v124
    v_sin_f32 v124, v124
    v_cos_f32 v109, v125
    v_sin_f32 v125, v125
    v_cos_f32 v110, v126
    v_sin_f32 v126, v126
    v_and_b32 v30, 31, v0
    v_mul_u32_u24 v30, 144, v30
    v_lshl_add_u32 v30, v21, 4, v30
    v_add_u32 v30, s81, v30
    v_add_u32 v31, 45056, v3
    v_add_u32 v19, 2048, v3
    v_min_u32 v19, 2576, v19
    s_bfe_u32 s82, s78, 0x20001
    s_mul_i32 s82, s82, 2688
    s_add_u32 s82, s82, 524288
    s_mul_i32 s83, s78, 10368
    s_mul_i32 s58, s26, 3072
    s_add_u32 s83, s83, s58
    s_add_u32 s83, s83, 7340032
    s_waitcnt vmcnt(16)
    s_barrier
    s_add_u32 m0, s68, 98304
    s_nop 0
    buffer_load_dwordx4 v3, s[36:39], s66 offen offset:0 sc1 lds
    buffer_load_dwordx4 v3, s[36:39], s66 offen offset:1024 sc1 lds
    buffer_load_dwordx4 v3, s[36:39], s66 offen offset:2048 sc1 lds
    buffer_load_dwordx4 v3, s[36:39], s66 offen offset:3072 sc1 lds
    s_add_u32 s66, s66, 4096
    s_add_u32 m0, s68, 114688
    s_add_u32 s58, s67, 573440
    buffer_load_dwordx4 v6, s[40:43], s58 offen offset:0 lds
    buffer_load_dwordx4 v7, s[40:43], s58 offen offset:1024 lds
    buffer_load_dwordx4 v8, s[40:43], s58 offen offset:2048 lds
    buffer_load_dwordx4 v9, s[40:43], s58 offen offset:3072 lds
    s_waitcnt vmcnt(16)
    s_barrier
    s_add_u32 m0, s68, 0
    s_nop 0
    buffer_load_dwordx4 v3, s[36:39], s66 offen offset:0 sc1 lds
    buffer_load_dwordx4 v3, s[36:39], s66 offen offset:1024 sc1 lds
    buffer_load_dwordx4 v3, s[36:39], s66 offen offset:2048 sc1 lds
    buffer_load_dwordx4 v3, s[36:39], s66 offen offset:3072 sc1 lds
    s_add_u32 s66, s66, 4096
    s_add_u32 m0, s68, 16384
    s_add_u32 s58, s67, 655360
    buffer_load_dwordx4 v6, s[40:43], s58 offen offset:0 lds
    buffer_load_dwordx4 v7, s[40:43], s58 offen offset:1024 lds
    buffer_load_dwordx4 v8, s[40:43], s58 offen offset:2048 lds
    buffer_load_dwordx4 v9, s[40:43], s58 offen offset:3072 lds
    s_waitcnt vmcnt(0)
    s_barrier
    s_mov_b32 s36, s28
    s_mov_b32 s37, s29
    s_mov_b32 s38, 12288
    s_mov_b32 s39, 0x00020000
    s_mul_i32 s73, s26, 3072
    s_add_u32 m0, s73, 45056
    s_nop 0
    buffer_load_dwordx4 v3, s[36:39], s73 offen offset:0 lds
    buffer_load_dwordx4 v3, s[36:39], s73 offen offset:1024 lds
    buffer_load_dwordx4 v3, s[36:39], s73 offen offset:2048 lds
    s_cmp_lg_u32 s26, 0
    s_cbranch_scc1 Lpo_24_w
    s_mov_b32 s30, 0
Lpo_24:
    buffer_load_dword v22, v3, s[48:51], s82 offen offset:0 sc1
    buffer_load_dword v23, v3, s[48:51], s82 offen offset:1024 sc1
    buffer_load_dword v24, v19, s[48:51], s82 offen offset:0 sc1
    s_waitcnt vmcnt(0)
    v_xor_b32 v22, s27, v22
    v_xor_b32 v23, s27, v23
    v_or_b32 v22, v22, v23
    v_xor_b32 v24, s27, v24
    v_or_b32 v22, v22, v24
    v_cmp_eq_u32 vcc, 0, v22
    s_nop 0
    s_cmp_eq_u64 vcc, -1
    s_cbranch_scc1 Lpo_24_ok
    s_add_u32 s30, s30, 1
    s_cmp_ge_u32 s30, 40000
    s_cbranch_scc1 Lpo_24_ok
    s_sleep 4
    s_branch Lpo_24
Lpo_24_ok:
    v_mov_b32 v26, 157520
    v_mov_b32 v22, 1
    v_mov_b32 v23, 1
    v_mov_b32 v24, 1
    v_mov_b32 v25, 1
    ds_write_b128 v26, v[22:25]
Lpo_24_w:
    v_mov_b32 v26, 157520
    s_mov_b32 s30, 0
Lfw_25:
    ds_read_b128 v[22:25], v26
    s_waitcnt lgkmcnt(0)
    v_and_b32 v22, v22, v23
    v_and_b32 v24, v24, v25
    v_and_b32 v22, v22, v24
    s_nop 0
    v_readfirstlane_b32 s58, v22
    s_add_u32 s30, s30, 1
    s_cmp_ge_u32 s30, 320000
    s_cselect_b32 s58, 1, s58
    s_cmp_eq_u32 s58, 0
    s_cbranch_scc1 Lfw_25
    s_add_u32 m0, s73, 32768
    s_nop 0
    buffer_load_dwordx4 v3, s[48:51], s83 offen offset:0 sc1 lds
    buffer_load_dwordx4 v3, s[48:51], s83 offen offset:1024 sc1 lds
    buffer_load_dwordx4 v3, s[48:51], s83 offen offset:2048 sc1 lds
    s_waitcnt vmcnt(0)
    s_lshl_b32 s58, s26, 2
    s_add_u32 s58, s58, 157536
    v_mov_b32 v22, s58
    v_mov_b32 v23, 1
    ds_write_b32 v22, v23
    v_mov_b32 v26, 157536
    s_mov_b32 s30, 0
Lfw_26:
    ds_read_b128 v[22:25], v26
    s_waitcnt lgkmcnt(0)
    v_and_b32 v22, v22, v23
    v_and_b32 v24, v24, v25
    v_and_b32 v22, v22, v24
    s_nop 0
    v_readfirstlane_b32 s58, v22
    s_add_u32 s30, s30, 1
    s_cmp_ge_u32 s30, 320000
    s_cselect_b32 s58, 1, s58
    s_cmp_eq_u32 s58, 0
    s_cbranch_scc1 Lfw_26
    ds_read_b128 v[48:51], v31 offset:0
    ds_read_b128 v[64:67], v31 offset:4096
    s_mov_b32 exec_lo, 0x07ff07ff
    s_mov_b32 exec_hi, 0x07ff07ff
    ds_read_b32 v32, v28 offset:0
    ds_read_b32 v33, v28 offset:320
    ds_read_b32 v34, v28 offset:640
    ds_read_b32 v35, v28 offset:960
    ds_read_b32 v36, v28 offset:2560
    ds_read_b32 v37, v28 offset:2880
    ds_read_b32 v38, v28 offset:3200
    ds_read_b32 v39, v28 offset:3520
    s_mov_b32 exec_lo, 0x03ff03ff
    s_mov_b32 exec_hi, 0x03fe03fe
    ds_read_b32 v40, v29 offset:3520
    s_mov_b32 exec_lo, 0x03fe03fe
    ds_read_b32 v41, v29 offset:3200
    ds_read_b32 v42, v29 offset:2880
    ds_read_b32 v43, v29 offset:2560
    ds_read_b32 v44, v29 offset:960
    ds_read_b32 v45, v29 offset:640
    ds_read_b32 v46, v29 offset:320
    ds_read_b32 v47, v29 offset:0
    s_mov_b64 exec, -1
    ds_read_b128 v[52:55], v31 offset:1024
    ds_read_b128 v[68:71], v31 offset:5120
    ds_read_b128 v[56:59], v31 offset:2048
    ds_read_b128 v[72:75], v31 offset:6144
    ds_read_b128 v[60:63], v31 offset:3072
    ds_read_b128 v[76:79], v31 offset:7168
    s_waitcnt lgkmcnt(0)
    ds_read_b128 v[80:83], v31 offset:8192
    ds_read_b128 v[84:87], v31 offset:9216
    ds_read_b128 v[88:91], v31 offset:10240
    ds_read_b128 v[92:95], v31 offset:11264
    v_mfma_f32_32x32x16_bf16 v[128:143], v[32:35], v[48:51], 0
    v_mfma_f32_32x32x16_bf16 v[144:159], v[32:35], v[64:67], 0
    v_mfma_f32_32x32x16_bf16 v[128:143], v[36:39], v[52:55], v[128:143]
    v_mfma_f32_32x32x16_bf16 v[144:159], v[36:39], v[68:71], v[144:159]
    v_mfma_f32_32x32x16_bf16 v[128:143], v[40:43], v[56:59], v[128:143]
    v_mfma_f32_32x32x16_bf16 v[144:159], v[40:43], v[72:75], v[144:159]
    v_mfma_f32_32x32x16_bf16 v[128:143], v[44:47], v[60:63], v[128:143]
    v_mfma_f32_32x32x16_bf16 v[144:159], v[44:47], v[76:79], v[144:159]
    s_nop 10
    v_mul_f32 v24, v128, v96
    v_mul_f32 v25, v144, v96
    v_fmac_f32 v24, v144, v112
    v_fma_f32 v25, -v128, v112, v25
    v_cvt_pk_bf16_f32 v32, v24, v25
    v_mul_f32 v26, v129, v97
    v_mul_f32 v27, v145, v97
    v_fmac_f32 v26, v145, v113
    v_fma_f32 v27, -v129, v113, v27
    v_cvt_pk_bf16_f32 v33, v26, v27
    v_mul_f32 v24, v130, v98
    v_mul_f32 v25, v146, v98
    v_fmac_f32 v24, v146, v114
    v_fma_f32 v25, -v130, v114, v25
    v_cvt_pk_bf16_f32 v34, v24, v25
    v_mul_f32 v26, v131, v99
    v_mul_f32 v27, v147, v99
    v_fmac_f32 v26, v147, v115
    v_fma_f32 v27, -v131, v115, v27
    v_cvt_pk_bf16_f32 v35, v26, v27
    v_mul_f32 v24, v132, v100
    v_mul_f32 v25, v148, v100
    v_fmac_f32 v24, v148, v116
    v_fma_f32 v25, -v132, v116, v25
    v_cvt_pk_bf16_f32 v36, v24, v25
    v_mul_f32 v26, v133, v101
    v_mul_f32 v27, v149, v101
    v_fmac_f32 v26, v149, v117
    v_fma_f32 v27, -v133, v117, v27
    v_cvt_pk_bf16_f32 v37, v26, v27
    v_mul_f32 v24, v134, v102
    v_mul_f32 v25, v150, v102
    v_fmac_f32 v24, v150, v118
    v_fma_f32 v25, -v134, v118, v25
    v_cvt_pk_bf16_f32 v38, v24, v25
    v_mul_f32 v24, v136, v104
    v_mul_f32 v25, v152, v104
    v_fmac_f32 v24, v152, v120
    v_fma_f32 v25, -v136, v120, v25
    v_cvt_pk_bf16_f32 v40, v24, v25
    v_mul_f32 v26, v137, v105
    v_mul_f32 v27, v153, v105
    v_fmac_f32 v26, v153, v121
    v_fma_f32 v27, -v137, v121, v27
    v_cvt_pk_bf16_f32 v41, v26, v27
    v_mul_f32 v24, v138, v106
    v_mul_f32 v25, v154, v106
    v_fmac_f32 v24, v154, v122
    v_fma_f32 v25, -v138, v122, v25
    v_cvt_pk_bf16_f32 v42, v24, v25
    v_mul_f32 v26, v139, v107
    v_mul_f32 v27, v155, v107
    v_fmac_f32 v26, v155, v123
    v_fma_f32 v27, -v139, v123, v27
    v_cvt_pk_bf16_f32 v43, v26, v27
    v_mul_f32 v24, v140, v108
    v_mul_f32 v25, v156, v108
    v_fmac_f32 v24, v156, v124
    v_fma_f32 v25, -v140, v124, v25
    v_cvt_pk_bf16_f32 v44, v24, v25
    v_mul_f32 v26, v141, v109
    v_mul_f32 v27, v157, v109
    v_fmac_f32 v26, v157, v125
    v_fma_f32 v27, -v141, v125, v27
    v_cvt_pk_bf16_f32 v45, v26, v27
    v_mul_f32 v24, v142, v110
    v_mul_f32 v25, v158, v110
    v_fmac_f32 v24, v158, v126
    v_fma_f32 v25, -v142, v126, v25
    v_cvt_pk_bf16_f32 v46, v24, v25
    v_mov_b32 v39, 0
    v_mov_b32 v47, 0
    s_waitcnt lgkmcnt(0)
    v_mfma_f32_32x32x16_bf16 v[128:143], v[32:35], v[80:83], 0
    v_mfma_f32_32x32x16_bf16 v[144:159], v[32:35], v[80:83], 0
    v_mfma_f32_32x32x16_bf16 v[128:143], v[36:39], v[84:87], v[128:143]
    v_mfma_f32_32x32x16_bf16 v[144:159], v[36:39], v[84:87], v[144:159]
    v_mfma_f32_32x32x16_bf16 v[128:143], v[40:43], v[80:83], v[128:143]
    v_mfma_f32_32x32x16_bf16 v[144:159], v[40:43], v[88:91], v[144:159]
    v_mfma_f32_32x32x16_bf16 v[128:143], v[44:47], v[84:87], v[128:143]
    v_mfma_f32_32x32x16_bf16 v[144:159], v[44:47], v[92:95], v[144:159]
    v_lshrrev_b32 v4, 2, v0
    v_mul_u32_u24 v4, 144, v4
    v_and_b32 v5, 3, v0
    v_lshl_add_u32 v4, v5, 5, v4
    v_add_u32 v4, s81, v4
    s_mov_b32 s36, s20
    s_mov_b32 s37, s21
    s_mov_b32 s38, 2621440
    s_mov_b32 s39, 0x00020000
    v_lshlrev_b32 v96, 16, v160
    v_and_b32 v97, 0xffff0000, v160
    v_lshlrev_b32 v98, 16, v161
    v_and_b32 v99, 0xffff0000, v161
    v_lshlrev_b32 v100, 16, v162
    v_and_b32 v101, 0xffff0000, v162
    v_lshlrev_b32 v102, 16, v163
    v_and_b32 v103, 0xffff0000, v163
    v_lshlrev_b32 v104, 16, v164
    v_and_b32 v105, 0xffff0000, v164
    v_lshlrev_b32 v106, 16, v165
    v_and_b32 v107, 0xffff0000, v165
    v_lshlrev_b32 v108, 16, v166
    v_and_b32 v109, 0xffff0000, v166
    v_lshlrev_b32 v110, 16, v167
    v_and_b32 v111, 0xffff0000, v167
    v_mov_b32 v26, 157552
    s_mov_b32 s30, 0
Lfw_27:
    ds_read_b128 v[22:25], v26
    s_waitcnt lgkmcnt(0)
    v_and_b32 v22, v22, v23
    v_and_b32 v24, v24, v25
    v_and_b32 v22, v22, v24
    s_nop 0
    v_readfirstlane_b32 s58, v22
    s_add_u32 s30, s30, 1
    s_cmp_ge_u32 s30, 320000
    s_cselect_b32 s58, 1, s58
    s_cmp_eq_u32 s58, 0
    s_cbranch_scc1 Lfw_27
    s_mov_b32 exec_lo, 0xfffff
    s_mov_b32 exec_hi, 0xfffff
    ds_write_b128 v30, v[128:131] offset:0
    ds_write_b128 v30, v[132:135] offset:32
    ds_write_b128 v30, v[136:139] offset:64
    ds_write_b128 v30, v[140:143] offset:96
    ds_write_b128 v30, v[144:147] offset:11520
    ds_write_b128 v30, v[148:151] offset:11552
    ds_write_b128 v30, v[152:155] offset:11584
    ds_write_b128 v30, v[156:159] offset:11616
    s_mov_b64 exec, -1
Lfin:
    s_waitcnt lgkmcnt(0)
    s_barrier
    ds_read_b128 v[32:35], v4 offset:0
    ds_read_b128 v[36:39], v4 offset:16
    ds_read_b128 v[40:43], v4 offset:32768
    ds_read_b128 v[44:47], v4 offset:32784
    s_mov_b64 exec, 0xffff
    ds_read_b128 v[48:51], v4 offset:2304
    ds_read_b128 v[52:55], v4 offset:2320
    ds_read_b128 v[56:59], v4 offset:35072
    ds_read_b128 v[60:63], v4 offset:35088
    s_mov_b64 exec, -1
    s_waitcnt lgkmcnt(4)
    v_pk_fma_f32 v[96:97], v[32:33], v[40:41], v[96:97]
    v_pk_fma_f32 v[98:99], v[34:35], v[42:43], v[98:99]
    v_pk_fma_f32 v[100:101], v[36:37], v[44:45], v[100:101]
    v_pk_fma_f32 v[102:103], v[38:39], v[46:47], v[102:103]
    v_cvt_pk_bf16_f32 v64, v96, v97
    v_cvt_pk_bf16_f32 v65, v98, v99
    v_cvt_pk_bf16_f32 v66, v100, v101
    v_cvt_pk_bf16_f32 v67, v102, v103
    buffer_store_dwordx4 v[64:67], v3, s[36:39], s80 offen offset:0 sc1
    s_waitcnt lgkmcnt(0)
    s_mov_b64 exec, 0xffff
    v_pk_fma_f32 v[104:105], v[48:49], v[56:57], v[104:105]
    v_pk_fma_f32 v[106:107], v[50:51], v[58:59], v[106:107]
    v_pk_fma_f32 v[108:109], v[52:53], v[60:61], v[108:109]
    v_pk_fma_f32 v[110:111], v[54:55], v[62:63], v[110:111]
    v_cvt_pk_bf16_f32 v68, v104, v105
    v_cvt_pk_bf16_f32 v69, v106, v107
    v_cvt_pk_bf16_f32 v70, v108, v109
    v_cvt_pk_bf16_f32 v71, v110, v111
    buffer_store_dwordx4 v[68:71], v3, s[36:39], s80 offen offset:1024 sc1
    s_endpgm
Lfft:
    s_setprio 3
    s_cmp_ge_u32 s61, 28
    s_cbranch_scc1 Lfft_ng
    s_lshl_b32 s68, s60, 2
    s_add_u32 s68, s68, s26
    s_lshl_b32 s68, s68, 5
    s_add_u32 s68, s68, s61
    v_lshrrev_b32 v20, 5, v0
    v_and_b32 v21, 31, v0
    v_mul_u32_u24 v10, 320, v20
    v_add_lshl_u32 v10, v10, v21, 1
    s_mul_i32 s58, s68, 1280
    v_lshlrev_b32 v11, 4, v0
    v_add_u32 v13, 1309440, v11
    v_cmp_gt_u32 vcc, 16, v0
    s_nop 1
    v_cndmask_b32 v12, v13, v11, vcc
    v_add_u32 v16, 157328, v11
    v_mov_b32 v24, 0
    v_mov_b32 v25, 0
    v_mov_b32 v26, 0
    v_mov_b32 v27, 0
    s_mov_b64 exec, 0xffff
    ds_write_b128 v16, v[24:27]
    s_mov_b64 exec, -1
    s_waitcnt lgkmcnt(0)
    s_mov_b32 s32, s4
    s_mov_b32 s33, s5
    s_mov_b32 s34, 2621440
    s_mov_b32 s35, 0x00020000
    s_mul_i32 s64, s26, 3072
    s_add_u32 s64, s64, 98304
    s_mov_b32 m0, s64
    s_nop 0
    buffer_load_dwordx4 v11, s[32:35], s58 offen lds
    buffer_load_dwordx4 v12, s[32:35], s58 offen offset:1024 lds
    s_mov_b32 exec_hi, 0
    buffer_load_dwordx4 v13, s[32:35], s58 offen offset:2048 lds
    s_mov_b64 exec, -1
    s_barrier
    s_setprio 1
    v_cvt_f32_u32 v26, v20
    v_mul_f32 v26, 4.0, v26
    v_and_b32 v27, 15, v0
    v_cvt_f32_u32 v22, v27
    v_mul_f32 v22, 0x3acccccd, v22
    v_mul_f32 v23, v26, v22
    v_cvt_f32_u32 v24, s68
    v_mul_f32 v24, 0x3a000000, v24
    v_bfe_u32 v25, v0, 4, 1
    v_cvt_f32_u32 v25, v25
    v_fmac_f32 v23, v24, v25
    v_add_u32 v16, 114688, v11
    ds_read_b128 v[96:99], v16 offset:0
    ds_read_b128 v[100:103], v16 offset:1024
    ds_read_b128 v[104:107], v16 offset:2048
    ds_read_b128 v[108:111], v16 offset:3072
    ds_read_b128 v[112:115], v16 offset:4096
    ds_read_b128 v[116:119], v16 offset:5120
    ds_read_b128 v[120:123], v16 offset:6144
    ds_read_b128 v[124:127], v16 offset:7168
    ds_read_b128 v[128:131], v16 offset:8192
    ds_read_b128 v[132:135], v16 offset:9216
    ds_read_b128 v[136:139], v16 offset:10240
    ds_read_b128 v[140:143], v16 offset:11264
    ds_read_b128 v[144:147], v16 offset:12288
    ds_read_b128 v[148:151], v16 offset:13312
    v_fmamk_f32 v80, v22, 0x00000000, v23
    v_fmamk_f32 v81, v22, 0x3f800000, v23
    v_fmamk_f32 v82, v22, 0x40000000, v23
    v_fmamk_f32 v83, v22, 0x40400000, v23
    v_fmamk_f32 v84, v22, 0x41000000, v23
    v_fmamk_f32 v85, v22, 0x41100000, v23
    v_fmamk_f32 v86, v22, 0x41200000, v23
    v_fmamk_f32 v87, v22, 0x41300000, v23
    v_fmamk_f32 v88, v22, 0x41800000, v23
    v_fmamk_f32 v89, v22, 0x41880000, v23
    v_fmamk_f32 v90, v22, 0x41900000, v23
    v_fmamk_f32 v91, v22, 0x41980000, v23
    v_fmamk_f32 v92, v22, 0x41c00000, v23
    v_fmamk_f32 v93, v22, 0x41c80000, v23
    v_fmamk_f32 v94, v22, 0x41d00000, v23
    v_fmamk_f32 v95, v22, 0x41d80000, v23
    v_cos_f32 v64, v80
    v_sin_f32 v80, v80
    v_cos_f32 v65, v81
    v_sin_f32 v81, v81
    v_cos_f32 v66, v82
    v_sin_f32 v82, v82
    v_cos_f32 v67, v83
    v_sin_f32 v83, v83
    v_cos_f32 v68, v84
    v_sin_f32 v84, v84
    v_cos_f32 v69, v85
    v_sin_f32 v85, v85
    v_cos_f32 v70, v86
    v_sin_f32 v86, v86
    v_cos_f32 v71, v87
    v_sin_f32 v87, v87
    v_cos_f32 v72, v88
    v_sin_f32 v88, v88
    v_cos_f32 v73, v89
    v_sin_f32 v89, v89
    v_cos_f32 v74, v90
    v_sin_f32 v90, v90
    v_cos_f32 v75, v91
    v_sin_f32 v91, v91
    v_cos_f32 v76, v92
    v_sin_f32 v92, v92
    v_cos_f32 v77, v93
    v_sin_f32 v93, v93
    v_cos_f32 v78, v94
    v_sin_f32 v94, v94
    v_cos_f32 v79, v95
    v_sin_f32 v95, v95
    v_mul_u32_u24 v22, 84, v21
    v_sub_u32 v23, 2684, v22
    v_cmp_gt_u32 vcc, 16, v21
    s_nop 1
    v_cndmask_b32 v22, v23, v22, vcc
    v_mov_b32 v23, -4
    v_cndmask_b32_e64 v23, v23, 4, vcc
    s_mul_i32 s58, s26, 1360
    s_add_u32 s58, s58, 131072
    v_add_u32 v22, s58, v22
    v_lshlrev_b32 v20, 2, v20
    v_mad_i32_i24 v22, v23, v20, v22
    v_mad_i32_i24 v2, v23, 0, v22
    v_mad_i32_i24 v3, v23, 1, v22
    v_mad_i32_i24 v4, v23, 2, v22
    v_mad_i32_i24 v5, v23, 3, v22
    v_mad_i32_i24 v6, v23, 8, v22
    v_mad_i32_i24 v7, v23, 9, v22
    v_mad_i32_i24 v8, v23, 10, v22
    v_and_b32 v9, 47, v0
    v_cmp_eq_u32 vcc, 0, v9
    v_mov_b32 v9, 1.0
    s_nop 0
    v_cndmask_b32_e64 v9, v9, 0.5, vcc
    v_add_u32 v10, s64, v10
    s_waitcnt vmcnt(0) lgkmcnt(0)
    ds_read_u16_d16_hi v32, v10 offset:0
    ds_read_u16_d16_hi v33, v10 offset:64
    ds_read_u16_d16_hi v34, v10 offset:128
    ds_read_u16_d16_hi v35, v10 offset:192
    ds_read_u16_d16_hi v36, v10 offset:256
    ds_read_u16_d16_hi v37, v10 offset:320
    ds_read_u16_d16_hi v38, v10 offset:384
    ds_read_u16_d16_hi v39, v10 offset:448
    ds_read_u16_d16_hi v40, v10 offset:512
    ds_read_u16_d16_hi v41, v10 offset:576
    ds_read_u16_d16_hi v42, v10 offset:1280
    ds_read_u16_d16_hi v43, v10 offset:1344
    ds_read_u16_d16_hi v44, v10 offset:1408
    ds_read_u16_d16_hi v45, v10 offset:1472
    ds_read_u16_d16_hi v46, v10 offset:1536
    s_waitcnt lgkmcnt(5)
    ds_read_u16_d16_hi v47, v10 offset:1600
    ds_read_u16_d16_hi v48, v10 offset:1664
    ds_read_u16_d16_hi v49, v10 offset:1728
    ds_read_u16_d16_hi v50, v10 offset:1792
    ds_read_u16_d16_hi v51, v10 offset:1856
    v_add_f32 v26, v32, v33
    v_add_f32 v26, v26, v34
    v_add_f32 v26, v26, v35
    v_add_f32 v26, v26, v36
    v_add_f32 v26, v26, v37
    v_add_f32 v26, v26, v38
    v_add_f32 v26, v26, v39
    v_add_f32 v26, v26, v40
    v_add_f32 v26, v26, v41
    s_waitcnt lgkmcnt(0)
    v_add_f32 v27, v42, v43
    v_add_f32 v27, v27, v44
    v_add_f32 v27, v27, v45
    v_add_f32 v27, v27, v46
    v_add_f32 v27, v27, v47
    v_add_f32 v27, v27, v48
    v_add_f32 v27, v27, v49
    v_add_f32 v27, v27, v50
    v_add_f32 v27, v27, v51
    v_add_f32_dpp v26, v26, v26 row_shr:1 row_mask:0xf bank_mask:0xf
    s_nop 0
    v_add_f32_dpp v27, v27, v27 row_shr:1 row_mask:0xf bank_mask:0xf
    v_add_f32_dpp v26, v26, v26 row_shr:2 row_mask:0xf bank_mask:0xf
    s_nop 0
    v_add_f32_dpp v27, v27, v27 row_shr:2 row_mask:0xf bank_mask:0xf
    v_add_f32_dpp v26, v26, v26 row_shr:4 row_mask:0xf bank_mask:0xf
    s_nop 0
    v_add_f32_dpp v27, v27, v27 row_shr:4 row_mask:0xf bank_mask:0xf
    v_add_f32_dpp v26, v26, v26 row_shr:8 row_mask:0xf bank_mask:0xf
    s_nop 0
    v_add_f32_dpp v27, v27, v27 row_shr:8 row_mask:0xf bank_mask:0xf
    v_add_f32_dpp v26, v26, v26 row_bcast:15 row_mask:0xa bank_mask:0xf
    s_nop 0
    v_add_f32_dpp v27, v27, v27 row_bcast:15 row_mask:0xa bank_mask:0xf
    v_add_f32_dpp v26, v26, v26 row_bcast:31 row_mask:0xc bank_mask:0xf
    s_nop 0
    v_add_f32_dpp v27, v27, v27 row_bcast:31 row_mask:0xc bank_mask:0xf
    v_readlane_b32 s58, v26, 63
    v_readlane_b32 s59, v27, 63
    v_mov_b32 v28, 0x3acccccd
    s_nop 0
    v_mul_f32 v29, s59, v28
    v_mul_f32 v28, s58, v28
    v_sub_f32 v32, v32, v28
    v_sub_f32 v42, v42, v29
    v_sub_f32 v33, v33, v28
    v_sub_f32 v43, v43, v29
    v_sub_f32 v34, v34, v28
    v_sub_f32 v44, v44, v29
    v_sub_f32 v35, v35, v28
    v_sub_f32 v45, v45, v29
    v_sub_f32 v36, v36, v28
    v_sub_f32 v46, v46, v29
    v_sub_f32 v37, v37, v28
    v_sub_f32 v47, v47, v29
    v_sub_f32 v38, v38, v28
    v_sub_f32 v48, v48, v29
    v_sub_f32 v39, v39, v28
    v_sub_f32 v49, v49, v29
    v_sub_f32 v40, v40, v28
    v_sub_f32 v50, v50, v29
    v_sub_f32 v41, v41, v28
    v_sub_f32 v51, v51, v29
    v_mul_f32 v26, v32, v32
    v_mul_f32 v27, v42, v42
    v_fmac_f32 v26, v33, v33
    v_fmac_f32 v27, v43, v43
    v_fmac_f32 v26, v34, v34
    v_fmac_f32 v27, v44, v44
    v_fmac_f32 v26, v35, v35
    v_fmac_f32 v27, v45, v45
    v_fmac_f32 v26, v36, v36
    v_fmac_f32 v27, v46, v46
    v_fmac_f32 v26, v37, v37
    v_fmac_f32 v27, v47, v47
    v_fmac_f32 v26, v38, v38
    v_fmac_f32 v27, v48, v48
    v_fmac_f32 v26, v39, v39
    v_fmac_f32 v27, v49, v49
    v_fmac_f32 v26, v40, v40
    v_fmac_f32 v27, v50, v50
    v_fmac_f32 v26, v41, v41
    v_fmac_f32 v27, v51, v51
    s_nop 0
    v_add_f32_dpp v26, v26, v26 row_shr:1 row_mask:0xf bank_mask:0xf
    v_add_f32_dpp v27, v27, v27 row_shr:1 row_mask:0xf bank_mask:0xf
    s_nop 0
    v_add_f32_dpp v26, v26, v26 row_shr:2 row_mask:0xf bank_mask:0xf
    v_add_f32_dpp v27, v27, v27 row_shr:2 row_mask:0xf bank_mask:0xf
    s_nop 0
    v_add_f32_dpp v26, v26, v26 row_shr:4 row_mask:0xf bank_mask:0xf
    v_add_f32_dpp v27, v27, v27 row_shr:4 row_mask:0xf bank_mask:0xf
    s_nop 0
    v_add_f32_dpp v26, v26, v26 row_shr:8 row_mask:0xf bank_mask:0xf
    v_add_f32_dpp v27, v27, v27 row_shr:8 row_mask:0xf bank_mask:0xf
    s_nop 0
    v_add_f32_dpp v26, v26, v26 row_bcast:15 row_mask:0xa bank_mask:0xf
    v_add_f32_dpp v27, v27, v27 row_bcast:15 row_mask:0xa bank_mask:0xf
    s_nop 0
    v_add_f32_dpp v26, v26, v26 row_bcast:31 row_mask:0xc bank_mask:0xf
    v_add_f32_dpp v27, v27, v27 row_bcast:31 row_mask:0xc bank_mask:0xf
    v_readlane_b32 s58, v26, 63
    v_readlane_b32 s59, v27, 63
    s_nop 0
    v_mov_b32 v26, s58
    v_mov_b32 v27, s59
    v_mov_b32 v16, 0x3727c5ac
    v_mul_f32 v26, 0x3acccccd, v26
    v_add_f32 v30, v26, v16
    v_rsq_f32 v30, v30
    s_nop 0
    v_mul_f32 v26, v26, v30
    v_fma_f32 v26, v26, v30, v16
    v_rsq_f32 v15, v26
    s_nop 0
    v_mul_f32 v15, v15, v30
    v_mov_b32 v16, 0x3727c5ac
    v_mul_f32 v27, 0x3acccccd, v27
    v_add_f32 v31, v27, v16
    v_rsq_f32 v31, v31
    s_nop 0
    v_mul_f32 v27, v27, v31
    v_fma_f32 v27, v27, v31, v16
    v_rsq_f32 v17, v27
    s_nop 0
    v_mul_f32 v17, v17, v31
    v_mov_b32 v12, v28
    v_mov_b32 v13, v15
    v_mov_b32 v14, v29
    v_mov_b32 v15, v17
    s_lshl_b32 s58, s26, 4
    s_add_u32 s58, s58, 157600
    v_mov_b32 v16, s58
    ds_write_b128 v16, v[12:15]
    v_mul_f32 v42, v42, v31
    v_mul_f32 v43, v43, v31
    v_mul_f32 v44, v44, v31
    v_mul_f32 v45, v45, v31
    v_mul_f32 v46, v46, v31
    v_mul_f32 v47, v47, v31
    v_mul_f32 v48, v48, v31
    v_mul_f32 v49, v49, v31
    v_mul_f32 v50, v50, v31
    v_mul_f32 v51, v51, v31
    v_fma_f32 v18, v32, v30, v42
    v_fma_f32 v19, v33, v30, v43
    v_fma_f32 v20, v32, v30, -v42
    v_fma_f32 v21, v33, v30, -v43
    v_cvt_pk_bf16_f32 v152, v18, v19
    v_cvt_pk_bf16_f32 v157, v20, v21
    v_fma_f32 v18, v34, v30, v44
    v_fma_f32 v19, v35, v30, v45
    v_fma_f32 v20, v34, v30, -v44
    v_fma_f32 v21, v35, v30, -v45
    v_cvt_pk_bf16_f32 v153, v18, v19
    v_cvt_pk_bf16_f32 v158, v20, v21
    v_fma_f32 v18, v36, v30, v46
    v_fma_f32 v19, v37, v30, v47
    v_fma_f32 v20, v36, v30, -v46
    v_fma_f32 v21, v37, v30, -v47
    v_cvt_pk_bf16_f32 v154, v18, v19
    v_cvt_pk_bf16_f32 v159, v20, v21
    v_fma_f32 v18, v38, v30, v48
    v_fma_f32 v19, v39, v30, v49
    v_fma_f32 v20, v38, v30, -v48
    v_fma_f32 v21, v39, v30, -v49
    v_cvt_pk_bf16_f32 v155, v18, v19
    v_cvt_pk_bf16_f32 v160, v20, v21
    v_fma_f32 v18, v40, v30, v50
    v_fma_f32 v19, v41, v30, v51
    v_fma_f32 v20, v40, v30, -v50
    v_fma_f32 v21, v41, v30, -v51
    v_cvt_pk_bf16_f32 v156, v18, v19
    v_cvt_pk_bf16_f32 v161, v20, v21
    v_mov_b32 v162, 0
    v_mov_b32 v163, 0
    v_mfma_f32_32x32x16_bf16 v[32:47], v[152:155], v[96:99], 0
    v_mfma_f32_32x32x16_bf16 v[48:63], v[152:155], v[108:111], 0
    v_mfma_f32_32x32x16_bf16 v[32:47], v[156:159], v[100:103], v[32:47]
    v_mfma_f32_32x32x16_bf16 v[48:63], v[156:159], v[112:115], v[48:63]
    v_mfma_f32_32x32x16_bf16 v[32:47], v[160:163], v[104:107], v[32:47]
    v_mfma_f32_32x32x16_bf16 v[48:63], v[160:163], v[116:119], v[48:63]
    s_nop 10
    v_mul_f32 v18, v32, v64
    v_mul_f32 v19, v48, v64
    v_fmac_f32 v18, v48, v80
    v_fma_f32 v19, -v32, v80, v19
    v_cvt_pk_bf16_f32 v152, v18, v19
    v_mul_f32 v20, v33, v65
    v_mul_f32 v21, v49, v65
    v_fmac_f32 v20, v49, v81
    v_fma_f32 v21, -v33, v81, v21
    v_cvt_pk_bf16_f32 v153, v20, v21
    v_mul_f32 v18, v34, v66
    v_mul_f32 v19, v50, v66
    v_fmac_f32 v18, v50, v82
    v_fma_f32 v19, -v34, v82, v19
    v_cvt_pk_bf16_f32 v154, v18, v19
    v_mul_f32 v20, v35, v67
    v_mul_f32 v21, v51, v67
    v_fmac_f32 v20, v51, v83
    v_fma_f32 v21, -v35, v83, v21
    v_cvt_pk_bf16_f32 v155, v20, v21
    v_mul_f32 v18, v36, v68
    v_mul_f32 v19, v52, v68
    v_fmac_f32 v18, v52, v84
    v_fma_f32 v19, -v36, v84, v19
    v_cvt_pk_bf16_f32 v156, v18, v19
    v_mul_f32 v20, v37, v69
    v_mul_f32 v21, v53, v69
    v_fmac_f32 v20, v53, v85
    v_fma_f32 v21, -v37, v85, v21
    v_cvt_pk_bf16_f32 v157, v20, v21
    v_mul_f32 v18, v38, v70
    v_mul_f32 v19, v54, v70
    v_fmac_f32 v18, v54, v86
    v_fma_f32 v19, -v38, v86, v19
    v_cvt_pk_bf16_f32 v158, v18, v19
    v_mul_f32 v20, v39, v71
    v_mul_f32 v21, v55, v71
    v_fmac_f32 v20, v55, v87
    v_fma_f32 v21, -v39, v87, v21
    v_cvt_pk_bf16_f32 v159, v20, v21
    v_mul_f32 v18, v40, v72
    v_mul_f32 v19, v56, v72
    v_fmac_f32 v18, v56, v88
    v_fma_f32 v19, -v40, v88, v19
    v_cvt_pk_bf16_f32 v160, v18, v19
    v_mul_f32 v20, v41, v73
    v_mul_f32 v21, v57, v73
    v_fmac_f32 v20, v57, v89
    v_fma_f32 v21, -v41, v89, v21
    v_cvt_pk_bf16_f32 v161, v20, v21
    v_mul_f32 v18, v42, v74
    v_mul_f32 v19, v58, v74
    v_fmac_f32 v18, v58, v90
    v_fma_f32 v19, -v42, v90, v19
    v_cvt_pk_bf16_f32 v162, v18, v19
    v_mul_f32 v20, v43, v75
    v_mul_f32 v21, v59, v75
    v_fmac_f32 v20, v59, v91
    v_fma_f32 v21, -v43, v91, v21
    v_cvt_pk_bf16_f32 v163, v20, v21
    v_mul_f32 v18, v44, v76
    v_mul_f32 v19, v60, v76
    v_fmac_f32 v18, v60, v92
    v_fma_f32 v19, -v44, v92, v19
    v_cvt_pk_bf16_f32 v164, v18, v19
    v_mul_f32 v20, v45, v77
    v_mul_f32 v21, v61, v77
    v_fmac_f32 v20, v61, v93
    v_fma_f32 v21, -v45, v93, v21
    v_cvt_pk_bf16_f32 v165, v20, v21
    v_mul_f32 v18, v46, v78
    v_mul_f32 v19, v62, v78
    v_fmac_f32 v18, v62, v94
    v_fma_f32 v19, -v46, v94, v19
    v_cvt_pk_bf16_f32 v166, v18, v19
    v_mul_f32 v20, v47, v79
    v_mul_f32 v21, v63, v79
    v_fmac_f32 v20, v63, v95
    v_fma_f32 v21, -v47, v95, v21
    v_cvt_pk_bf16_f32 v167, v20, v21
    v_mfma_f32_32x32x16_bf16 v[32:47], v[152:155], v[120:123], 0
    v_mfma_f32_32x32x16_bf16 v[48:63], v[152:155], v[136:139], 0
    v_mfma_f32_32x32x16_bf16 v[32:47], v[156:159], v[124:127], v[32:47]
    v_mfma_f32_32x32x16_bf16 v[48:63], v[156:159], v[140:143], v[48:63]
    v_mfma_f32_32x32x16_bf16 v[32:47], v[160:163], v[128:131], v[32:47]
    v_mfma_f32_32x32x16_bf16 v[48:63], v[160:163], v[144:147], v[48:63]
    v_mfma_f32_32x32x16_bf16 v[32:47], v[164:167], v[132:135], v[32:47]
    v_mfma_f32_32x32x16_bf16 v[48:63], v[164:167], v[148:151], v[48:63]
    s_nop 10
    v_mul_f32 v32, v32, v9
    v_mul_f32 v48, v48, v9
    v_mul_f32 v40, v40, v9
    v_mul_f32 v56, v56, v9
    v_cvt_pk_bf16_f32 v152, v32, v48
    v_cvt_pk_bf16_f32 v153, v33, v49
    v_cvt_pk_bf16_f32 v154, v34, v50
    v_cvt_pk_bf16_f32 v155, v35, v51
    v_cvt_pk_bf16_f32 v156, v36, v52
    v_cvt_pk_bf16_f32 v157, v37, v53
    v_cvt_pk_bf16_f32 v158, v38, v54
    v_cvt_pk_bf16_f32 v160, v40, v56
    v_cvt_pk_bf16_f32 v161, v41, v57
    v_cvt_pk_bf16_f32 v162, v42, v58
    v_cvt_pk_bf16_f32 v163, v43, v59
    v_cvt_pk_bf16_f32 v164, v44, v60
    v_cvt_pk_bf16_f32 v165, v45, v61
    v_cvt_pk_bf16_f32 v166, v46, v62
    ds_write_b32 v3, v153 offset:0
    ds_write_b32 v4, v154 offset:0
    ds_write_b32 v5, v155 offset:0
    ds_write_b32 v3, v161 offset:5440
    ds_write_b32 v4, v162 offset:5440
    ds_write_b32 v5, v163 offset:5440
    s_mov_b32 exec_lo, 0x1ffff
    ds_write_b32 v2, v152 offset:0
    ds_write_b32 v2, v160 offset:5440
    s_mov_b32 exec_lo, -1
    s_mov_b32 exec_hi, 0
    ds_write_b32 v6, v156 offset:0
    ds_write_b32 v7, v157 offset:0
    ds_write_b32 v6, v164 offset:5440
    ds_write_b32 v7, v165 offset:5440
    s_mov_b32 exec_lo, 0xffff
    ds_write_b32 v8, v158 offset:0
    ds_write_b32 v8, v166 offset:5440
    s_mov_b64 exec, -1
    s_waitcnt lgkmcnt(0)
    s_endpgm
Lfft_ng:
    s_lshl_b32 s68, s60, 2
    s_add_u32 s68, s68, s26
    s_lshl_b32 s68, s68, 5
    s_add_u32 s68, s68, s61
    v_lshrrev_b32 v20, 5, v0
    v_and_b32 v21, 31, v0
    v_mul_u32_u24 v10, 320, v20
    v_add_lshl_u32 v10, v10, v21, 1
    s_mul_i32 s58, s68, 1280
    v_lshlrev_b32 v11, 4, v0
    v_add_u32 v13, 1309440, v11
    v_cmp_gt_u32 vcc, 16, v0
    s_nop 1
    v_cndmask_b32 v12, v13, v11, vcc
    v_add_u32 v16, 157328, v11
    v_mov_b32 v24, 0
    v_mov_b32 v25, 0
    v_mov_b32 v26, 0
    v_mov_b32 v27, 0
    s_mov_b64 exec, 0xffff
    ds_write_b128 v16, v[24:27]
    s_mov_b64 exec, -1
    s_waitcnt lgkmcnt(0)
    s_mov_b32 s32, s4
    s_mov_b32 s33, s5
    s_mov_b32 s34, 2621440
    s_mov_b32 s35, 0x00020000
    s_mul_i32 s64, s26, 3072
    s_add_u32 s64, s64, 98304
    s_mov_b32 m0, s64
    s_nop 0
    buffer_load_dwordx4 v11, s[32:35], s58 offen lds
    buffer_load_dwordx4 v12, s[32:35], s58 offen offset:1024 lds
    s_mov_b32 exec_hi, 0
    buffer_load_dwordx4 v13, s[32:35], s58 offen offset:2048 lds
    s_mov_b64 exec, -1
    s_barrier
    s_setprio 1
    v_cvt_f32_u32 v26, v20
    v_mul_f32 v26, 4.0, v26
    v_and_b32 v27, 15, v0
    v_cvt_f32_u32 v22, v27
    v_mul_f32 v22, 0x3acccccd, v22
    v_mul_f32 v23, v26, v22
    v_cvt_f32_u32 v24, s68
    v_mul_f32 v24, 0x3a000000, v24
    v_bfe_u32 v25, v0, 4, 1
    v_cvt_f32_u32 v25, v25
    v_fmac_f32 v23, v24, v25
    v_add_u32 v16, 114688, v11
    ds_read_b128 v[96:99], v16 offset:0
    ds_read_b128 v[100:103], v16 offset:1024
    ds_read_b128 v[104:107], v16 offset:2048
    ds_read_b128 v[108:111], v16 offset:3072
    ds_read_b128 v[112:115], v16 offset:4096
    ds_read_b128 v[116:119], v16 offset:5120
    ds_read_b128 v[120:123], v16 offset:6144
    ds_read_b128 v[124:127], v16 offset:7168
    ds_read_b128 v[128:131], v16 offset:8192
    ds_read_b128 v[132:135], v16 offset:9216
    ds_read_b128 v[136:139], v16 offset:10240
    ds_read_b128 v[140:143], v16 offset:11264
    ds_read_b128 v[144:147], v16 offset:12288
    ds_read_b128 v[148:151], v16 offset:13312
    v_fmamk_f32 v80, v22, 0x00000000, v23
    v_fmamk_f32 v81, v22, 0x3f800000, v23
    v_fmamk_f32 v82, v22, 0x40000000, v23
    v_fmamk_f32 v83, v22, 0x40400000, v23
    v_fmamk_f32 v84, v22, 0x41000000, v23
    v_fmamk_f32 v85, v22, 0x41100000, v23
    v_fmamk_f32 v86, v22, 0x41200000, v23
    v_fmamk_f32 v87, v22, 0x41300000, v23
    v_fmamk_f32 v88, v22, 0x41800000, v23
    v_fmamk_f32 v89, v22, 0x41880000, v23
    v_fmamk_f32 v90, v22, 0x41900000, v23
    v_fmamk_f32 v91, v22, 0x41980000, v23
    v_fmamk_f32 v92, v22, 0x41c00000, v23
    v_fmamk_f32 v93, v22, 0x41c80000, v23
    v_fmamk_f32 v94, v22, 0x41d00000, v23
    v_fmamk_f32 v95, v22, 0x41d80000, v23
    v_cos_f32 v64, v80
    v_sin_f32 v80, v80
    v_cos_f32 v65, v81
    v_sin_f32 v81, v81
    v_cos_f32 v66, v82
    v_sin_f32 v82, v82
    v_cos_f32 v67, v83
    v_sin_f32 v83, v83
    v_cos_f32 v68, v84
    v_sin_f32 v84, v84
    v_cos_f32 v69, v85
    v_sin_f32 v85, v85
    v_cos_f32 v70, v86
    v_sin_f32 v86, v86
    v_cos_f32 v71, v87
    v_sin_f32 v87, v87
    v_cos_f32 v72, v88
    v_sin_f32 v88, v88
    v_cos_f32 v73, v89
    v_sin_f32 v89, v89
    v_cos_f32 v74, v90
    v_sin_f32 v90, v90
    v_cos_f32 v75, v91
    v_sin_f32 v91, v91
    v_cos_f32 v76, v92
    v_sin_f32 v92, v92
    v_cos_f32 v77, v93
    v_sin_f32 v93, v93
    v_cos_f32 v78, v94
    v_sin_f32 v94, v94
    v_cos_f32 v79, v95
    v_sin_f32 v95, v95
    v_mul_u32_u24 v22, 84, v21
    v_sub_u32 v23, 2684, v22
    v_cmp_gt_u32 vcc, 16, v21
    s_nop 1
    v_cndmask_b32 v22, v23, v22, vcc
    v_mov_b32 v23, -4
    v_cndmask_b32_e64 v23, v23, 4, vcc
    s_mul_i32 s58, s26, 1360
    s_add_u32 s58, s58, 131072
    v_add_u32 v22, s58, v22
    v_lshlrev_b32 v20, 2, v20
    v_mad_i32_i24 v22, v23, v20, v22
    v_mad_i32_i24 v2, v23, 0, v22
    v_mad_i32_i24 v3, v23, 1, v22
    v_mad_i32_i24 v4, v23, 2, v22
    v_mad_i32_i24 v5, v23, 3, v22
    v_mad_i32_i24 v6, v23, 8, v22
    v_mad_i32_i24 v7, v23, 9, v22
    v_mad_i32_i24 v8, v23, 10, v22
    v_and_b32 v9, 47, v0
    v_cmp_eq_u32 vcc, 0, v9
    v_mov_b32 v9, 1.0
    s_nop 0
    v_cndmask_b32_e64 v9, v9, 0.5, vcc
    v_add_u32 v10, s64, v10
    s_waitcnt vmcnt(0) lgkmcnt(0)
    ds_read_u16_d16_hi v32, v10 offset:0
    ds_read_u16_d16_hi v33, v10 offset:64
    ds_read_u16_d16_hi v34, v10 offset:128
    ds_read_u16_d16_hi v35, v10 offset:192
    ds_read_u16_d16_hi v36, v10 offset:256
    ds_read_u16_d16_hi v37, v10 offset:320
    ds_read_u16_d16_hi v38, v10 offset:384
    ds_read_u16_d16_hi v39, v10 offset:448
    ds_read_u16_d16_hi v40, v10 offset:512
    ds_read_u16_d16_hi v41, v10 offset:576
    ds_read_u16_d16_hi v42, v10 offset:1280
    ds_read_u16_d16_hi v43, v10 offset:1344
    ds_read_u16_d16_hi v44, v10 offset:1408
    ds_read_u16_d16_hi v45, v10 offset:1472
    ds_read_u16_d16_hi v46, v10 offset:1536
    s_waitcnt lgkmcnt(5)
    ds_read_u16_d16_hi v47, v10 offset:1600
    ds_read_u16_d16_hi v48, v10 offset:1664
    ds_read_u16_d16_hi v49, v10 offset:1728
    ds_read_u16_d16_hi v50, v10 offset:1792
    ds_read_u16_d16_hi v51, v10 offset:1856
    v_add_f32 v26, v32, v33
    v_add_f32 v26, v26, v34
    v_add_f32 v26, v26, v35
    v_add_f32 v26, v26, v36
    v_add_f32 v26, v26, v37
    v_add_f32 v26, v26, v38
    v_add_f32 v26, v26, v39
    v_add_f32 v26, v26, v40
    v_add_f32 v26, v26, v41
    s_waitcnt lgkmcnt(0)
    v_add_f32 v27, v42, v43
    v_add_f32 v27, v27, v44
    v_add_f32 v27, v27, v45
    v_add_f32 v27, v27, v46
    v_add_f32 v27, v27, v47
    v_add_f32 v27, v27, v48
    v_add_f32 v27, v27, v49
    v_add_f32 v27, v27, v50
    v_add_f32 v27, v27, v51
    v_add_f32_dpp v26, v26, v26 row_shr:1 row_mask:0xf bank_mask:0xf
    s_nop 0
    v_add_f32_dpp v27, v27, v27 row_shr:1 row_mask:0xf bank_mask:0xf
    v_add_f32_dpp v26, v26, v26 row_shr:2 row_mask:0xf bank_mask:0xf
    s_nop 0
    v_add_f32_dpp v27, v27, v27 row_shr:2 row_mask:0xf bank_mask:0xf
    v_add_f32_dpp v26, v26, v26 row_shr:4 row_mask:0xf bank_mask:0xf
    s_nop 0
    v_add_f32_dpp v27, v27, v27 row_shr:4 row_mask:0xf bank_mask:0xf
    v_add_f32_dpp v26, v26, v26 row_shr:8 row_mask:0xf bank_mask:0xf
    s_nop 0
    v_add_f32_dpp v27, v27, v27 row_shr:8 row_mask:0xf bank_mask:0xf
    v_add_f32_dpp v26, v26, v26 row_bcast:15 row_mask:0xa bank_mask:0xf
    s_nop 0
    v_add_f32_dpp v27, v27, v27 row_bcast:15 row_mask:0xa bank_mask:0xf
    v_add_f32_dpp v26, v26, v26 row_bcast:31 row_mask:0xc bank_mask:0xf
    s_nop 0
    v_add_f32_dpp v27, v27, v27 row_bcast:31 row_mask:0xc bank_mask:0xf
    v_readlane_b32 s58, v26, 63
    v_readlane_b32 s59, v27, 63
    v_mov_b32 v28, 0x3acccccd
    s_nop 0
    v_mul_f32 v29, s59, v28
    v_mul_f32 v28, s58, v28
    v_sub_f32 v32, v32, v28
    v_sub_f32 v42, v42, v29
    v_sub_f32 v33, v33, v28
    v_sub_f32 v43, v43, v29
    v_sub_f32 v34, v34, v28
    v_sub_f32 v44, v44, v29
    v_sub_f32 v35, v35, v28
    v_sub_f32 v45, v45, v29
    v_sub_f32 v36, v36, v28
    v_sub_f32 v46, v46, v29
    v_sub_f32 v37, v37, v28
    v_sub_f32 v47, v47, v29
    v_sub_f32 v38, v38, v28
    v_sub_f32 v48, v48, v29
    v_sub_f32 v39, v39, v28
    v_sub_f32 v49, v49, v29
    v_sub_f32 v40, v40, v28
    v_sub_f32 v50, v50, v29
    v_sub_f32 v41, v41, v28
    v_sub_f32 v51, v51, v29
    v_mul_f32 v26, v32, v32
    v_mul_f32 v27, v42, v42
    v_fmac_f32 v26, v33, v33
    v_fmac_f32 v27, v43, v43
    v_fmac_f32 v26, v34, v34
    v_fmac_f32 v27, v44, v44
    v_fmac_f32 v26, v35, v35
    v_fmac_f32 v27, v45, v45
    v_fmac_f32 v26, v36, v36
    v_fmac_f32 v27, v46, v46
    v_fmac_f32 v26, v37, v37
    v_fmac_f32 v27, v47, v47
    v_fmac_f32 v26, v38, v38
    v_fmac_f32 v27, v48, v48
    v_fmac_f32 v26, v39, v39
    v_fmac_f32 v27, v49, v49
    v_fmac_f32 v26, v40, v40
    v_fmac_f32 v27, v50, v50
    v_fmac_f32 v26, v41, v41
    v_fmac_f32 v27, v51, v51
    s_nop 0
    v_add_f32_dpp v26, v26, v26 row_shr:1 row_mask:0xf bank_mask:0xf
    v_add_f32_dpp v27, v27, v27 row_shr:1 row_mask:0xf bank_mask:0xf
    s_nop 0
    v_add_f32_dpp v26, v26, v26 row_shr:2 row_mask:0xf bank_mask:0xf
    v_add_f32_dpp v27, v27, v27 row_shr:2 row_mask:0xf bank_mask:0xf
    s_nop 0
    v_add_f32_dpp v26, v26, v26 row_shr:4 row_mask:0xf bank_mask:0xf
    v_add_f32_dpp v27, v27, v27 row_shr:4 row_mask:0xf bank_mask:0xf
    s_nop 0
    v_add_f32_dpp v26, v26, v26 row_shr:8 row_mask:0xf bank_mask:0xf
    v_add_f32_dpp v27, v27, v27 row_shr:8 row_mask:0xf bank_mask:0xf
    s_nop 0
    v_add_f32_dpp v26, v26, v26 row_bcast:15 row_mask:0xa bank_mask:0xf
    v_add_f32_dpp v27, v27, v27 row_bcast:15 row_mask:0xa bank_mask:0xf
    s_nop 0
    v_add_f32_dpp v26, v26, v26 row_bcast:31 row_mask:0xc bank_mask:0xf
    v_add_f32_dpp v27, v27, v27 row_bcast:31 row_mask:0xc bank_mask:0xf
    v_readlane_b32 s58, v26, 63
    v_readlane_b32 s59, v27, 63
    s_nop 0
    v_mov_b32 v26, s58
    v_mov_b32 v27, s59
    v_mov_b32 v16, 0x3727c5ac
    v_mul_f32 v26, 0x3acccccd, v26
    v_add_f32 v30, v26, v16
    v_rsq_f32 v30, v30
    s_nop 0
    v_mul_f32 v26, v26, v30
    v_fma_f32 v26, v26, v30, v16
    v_rsq_f32 v15, v26
    s_nop 0
    v_mul_f32 v15, v15, v30
    v_mov_b32 v16, 0x3727c5ac
    v_mul_f32 v27, 0x3acccccd, v27
    v_add_f32 v31, v27, v16
    v_rsq_f32 v31, v31
    s_nop 0
    v_mul_f32 v27, v27, v31
    v_fma_f32 v27, v27, v31, v16
    v_rsq_f32 v17, v27
    s_nop 0
    v_mul_f32 v17, v17, v31
    v_mov_b32 v12, v28
    v_mov_b32 v13, v15
    v_mov_b32 v14, v29
    v_mov_b32 v15, v17
    s_lshl_b32 s58, s26, 4
    s_add_u32 s58, s58, 157600
    v_mov_b32 v16, s58
    ds_write_b128 v16, v[12:15]
    v_mul_f32 v42, v42, v31
    v_mul_f32 v43, v43, v31
    v_mul_f32 v44, v44, v31
    v_mul_f32 v45, v45, v31
    v_mul_f32 v46, v46, v31
    v_mul_f32 v47, v47, v31
    v_mul_f32 v48, v48, v31
    v_mul_f32 v49, v49, v31
    v_mul_f32 v50, v50, v31
    v_mul_f32 v51, v51, v31
    v_fma_f32 v18, v32, v30, v42
    v_fma_f32 v19, v33, v30, v43
    v_fma_f32 v20, v32, v30, -v42
    v_fma_f32 v21, v33, v30, -v43
    v_cvt_pk_bf16_f32 v152, v18, v19
    v_cvt_pk_bf16_f32 v157, v20, v21
    v_fma_f32 v18, v34, v30, v44
    v_fma_f32 v19, v35, v30, v45
    v_fma_f32 v20, v34, v30, -v44
    v_fma_f32 v21, v35, v30, -v45
    v_cvt_pk_bf16_f32 v153, v18, v19
    v_cvt_pk_bf16_f32 v158, v20, v21
    v_fma_f32 v18, v36, v30, v46
    v_fma_f32 v19, v37, v30, v47
    v_fma_f32 v20, v36, v30, -v46
    v_fma_f32 v21, v37, v30, -v47
    v_cvt_pk_bf16_f32 v154, v18, v19
    v_cvt_pk_bf16_f32 v159, v20, v21
    v_fma_f32 v18, v38, v30, v48
    v_fma_f32 v19, v39, v30, v49
    v_fma_f32 v20, v38, v30, -v48
    v_fma_f32 v21, v39, v30, -v49
    v_cvt_pk_bf16_f32 v155, v18, v19
    v_cvt_pk_bf16_f32 v160, v20, v21
    v_fma_f32 v18, v40, v30, v50
    v_fma_f32 v19, v41, v30, v51
    v_fma_f32 v20, v40, v30, -v50
    v_fma_f32 v21, v41, v30, -v51
    v_cvt_pk_bf16_f32 v156, v18, v19
    v_cvt_pk_bf16_f32 v161, v20, v21
    v_mov_b32 v162, 0
    v_mov_b32 v163, 0
    v_mfma_f32_32x32x16_bf16 v[32:47], v[152:155], v[96:99], 0
    v_mfma_f32_32x32x16_bf16 v[48:63], v[152:155], v[108:111], 0
    v_mfma_f32_32x32x16_bf16 v[32:47], v[156:159], v[100:103], v[32:47]
    v_mfma_f32_32x32x16_bf16 v[48:63], v[156:159], v[112:115], v[48:63]
    v_mfma_f32_32x32x16_bf16 v[32:47], v[160:163], v[104:107], v[32:47]
    v_mfma_f32_32x32x16_bf16 v[48:63], v[160:163], v[116:119], v[48:63]
    s_mov_b32 s48, s24
    s_mov_b32 s49, s25
    s_mov_b32 s50, 16777216
    s_mov_b32 s51, 0x00020000
    s_mov_b32 s36, s22
    s_mov_b32 s37, s23
    s_mov_b32 s38, 256
    s_mov_b32 s39, 0x00020000
    s_lshl_b32 s71, s60, 4
    s_lshr_b32 s59, s61, 1
    s_add_u32 s71, s71, s59
    s_mul_i32 s71, s71, 20736
    s_and_b32 s59, s61, 1
    s_lshl_b32 s59, s59, 6
    s_add_u32 s71, s71, s59
    v_mov_b32 v25, 0
    buffer_load_dword v24, v25, s[36:39], 0 offen sc1
    v_mul_f32 v18, v32, v64
    v_mul_f32 v19, v48, v64
    v_fmac_f32 v18, v48, v80
    v_fma_f32 v19, -v32, v80, v19
    v_cvt_pk_bf16_f32 v152, v18, v19
    v_mul_f32 v20, v33, v65
    v_mul_f32 v21, v49, v65
    v_fmac_f32 v20, v49, v81
    v_fma_f32 v21, -v33, v81, v21
    v_cvt_pk_bf16_f32 v153, v20, v21
    v_mul_f32 v18, v34, v66
    v_mul_f32 v19, v50, v66
    v_fmac_f32 v18, v50, v82
    v_fma_f32 v19, -v34, v82, v19
    v_cvt_pk_bf16_f32 v154, v18, v19
    v_mul_f32 v20, v35, v67
    v_mul_f32 v21, v51, v67
    v_fmac_f32 v20, v51, v83
    v_fma_f32 v21, -v35, v83, v21
    v_cvt_pk_bf16_f32 v155, v20, v21
    v_mul_f32 v18, v36, v68
    v_mul_f32 v19, v52, v68
    v_fmac_f32 v18, v52, v84
    v_fma_f32 v19, -v36, v84, v19
    v_cvt_pk_bf16_f32 v156, v18, v19
    v_mul_f32 v20, v37, v69
    v_mul_f32 v21, v53, v69
    v_fmac_f32 v20, v53, v85
    v_fma_f32 v21, -v37, v85, v21
    v_cvt_pk_bf16_f32 v157, v20, v21
    v_mul_f32 v18, v38, v70
    v_mul_f32 v19, v54, v70
    v_fmac_f32 v18, v54, v86
    v_fma_f32 v19, -v38, v86, v19
    v_cvt_pk_bf16_f32 v158, v18, v19
    v_mul_f32 v20, v39, v71
    v_mul_f32 v21, v55, v71
    v_fmac_f32 v20, v55, v87
    v_fma_f32 v21, -v39, v87, v21
    v_cvt_pk_bf16_f32 v159, v20, v21
    v_mul_f32 v18, v40, v72
    v_mul_f32 v19, v56, v72
    v_fmac_f32 v18, v56, v88
    v_fma_f32 v19, -v40, v88, v19
    v_cvt_pk_bf16_f32 v160, v18, v19
    v_mul_f32 v20, v41, v73
    v_mul_f32 v21, v57, v73
    v_fmac_f32 v20, v57, v89
    v_fma_f32 v21, -v41, v89, v21
    v_cvt_pk_bf16_f32 v161, v20, v21
    v_mul_f32 v18, v42, v74
    v_mul_f32 v19, v58, v74
    v_fmac_f32 v18, v58, v90
    v_fma_f32 v19, -v42, v90, v19
    v_cvt_pk_bf16_f32 v162, v18, v19
    v_mul_f32 v20, v43, v75
    v_mul_f32 v21, v59, v75
    v_fmac_f32 v20, v59, v91
    v_fma_f32 v21, -v43, v91, v21
    v_cvt_pk_bf16_f32 v163, v20, v21
    v_mul_f32 v18, v44, v76
    v_mul_f32 v19, v60, v76
    v_fmac_f32 v18, v60, v92
    v_fma_f32 v19, -v44, v92, v19
    v_cvt_pk_bf16_f32 v164, v18, v19
    v_mul_f32 v20, v45, v77
    v_mul_f32 v21, v61, v77
    v_fmac_f32 v20, v61, v93
    v_fma_f32 v21, -v45, v93, v21
    v_cvt_pk_bf16_f32 v165, v20, v21
    v_mul_f32 v18, v46, v78
    v_mul_f32 v19, v62, v78
    v_fmac_f32 v18, v62, v94
    v_fma_f32 v19, -v46, v94, v19
    v_cvt_pk_bf16_f32 v166, v18, v19
    v_mul_f32 v20, v47, v79
    v_mul_f32 v21, v63, v79
    v_fmac_f32 v20, v63, v95
    v_fma_f32 v21, -v47, v95, v21
    v_cvt_pk_bf16_f32 v167, v20, v21
    v_mfma_f32_32x32x16_bf16 v[32:47], v[152:155], v[120:123], 0
    v_mfma_f32_32x32x16_bf16 v[48:63], v[152:155], v[136:139], 0
    v_mfma_f32_32x32x16_bf16 v[32:47], v[156:159], v[124:127], v[32:47]
    v_mfma_f32_32x32x16_bf16 v[48:63], v[156:159], v[140:143], v[48:63]
    v_mfma_f32_32x32x16_bf16 v[32:47], v[160:163], v[128:131], v[32:47]
    v_mfma_f32_32x32x16_bf16 v[48:63], v[160:163], v[144:147], v[48:63]
    v_mfma_f32_32x32x16_bf16 v[32:47], v[164:167], v[132:135], v[32:47]
    v_mfma_f32_32x32x16_bf16 v[48:63], v[164:167], v[148:151], v[48:63]
    s_nop 10
    v_mul_f32 v32, v32, v9
    v_mul_f32 v48, v48, v9
    v_mul_f32 v40, v40, v9
    v_mul_f32 v56, v56, v9
    v_cvt_pk_bf16_f32 v152, v32, v48
    v_cvt_pk_bf16_f32 v153, v33, v49
    v_cvt_pk_bf16_f32 v154, v34, v50
    v_cvt_pk_bf16_f32 v155, v35, v51
    v_cvt_pk_bf16_f32 v156, v36, v52
    v_cvt_pk_bf16_f32 v157, v37, v53
    v_cvt_pk_bf16_f32 v158, v38, v54
    v_cvt_pk_bf16_f32 v160, v40, v56
    v_cvt_pk_bf16_f32 v161, v41, v57
    v_cvt_pk_bf16_f32 v162, v42, v58
    v_cvt_pk_bf16_f32 v163, v43, v59
    v_cvt_pk_bf16_f32 v164, v44, v60
    v_cvt_pk_bf16_f32 v165, v45, v61
    v_cvt_pk_bf16_f32 v166, v46, v62
    ds_write_b32 v3, v153 offset:0
    ds_write_b32 v4, v154 offset:0
    ds_write_b32 v5, v155 offset:0
    ds_write_b32 v3, v161 offset:5440
    ds_write_b32 v4, v162 offset:5440
    ds_write_b32 v5, v163 offset:5440
    s_mov_b32 exec_lo, 0x1ffff
    ds_write_b32 v2, v152 offset:0
    ds_write_b32 v2, v160 offset:5440
    s_mov_b32 exec_lo, -1
    s_mov_b32 exec_hi, 0
    ds_write_b32 v6, v156 offset:0
    ds_write_b32 v7, v157 offset:0
    ds_write_b32 v6, v164 offset:5440
    ds_write_b32 v7, v165 offset:5440
    s_mov_b32 exec_lo, 0xffff
    ds_write_b32 v8, v158 offset:0
    ds_write_b32 v8, v166 offset:5440
    s_mov_b64 exec, -1
    s_waitcnt lgkmcnt(0)
    s_lshl_b32 s59, s26, 6
    s_add_u32 s72, s71, 1048576
    v_add_u32 v132, s59, v0
    v_cmp_lt_u32 vcc, 0x143, v132
    s_nop 1
    v_cndmask_b32_e64 v136, 0, 1, vcc
    v_mul_u32_u24 v133, 324, v136
    v_sub_u32 v133, v132, v133
    v_and_b32 v134, 3, v132
    v_lshlrev_b32 v135, 5, v132
    v_lshlrev_b32 v134, 4, v134
    v_sub_u32 v135, v135, v134
    v_mul_u32_u24 v134, 3277, v133
    v_lshrrev_b32 v134, 16, v134
    v_add_u32 v133, v133, v134
    v_min_u32 v133, 335, v133
    v_mul_u32_u24 v134, 5440, v136
    v_lshl_add_u32 v133, v133, 2, v134
    v_add_u32 v133, 131072, v133
    v_add_u32 v140, s59, v0
    v_add_u32 v140, 256, v140
    v_cmp_lt_u32 vcc, 0x143, v140
    s_nop 1
    v_cndmask_b32_e64 v144, 0, 1, vcc
    v_mul_u32_u24 v141, 324, v144
    v_sub_u32 v141, v140, v141
    v_and_b32 v142, 3, v140
    v_lshlrev_b32 v143, 5, v140
    v_lshlrev_b32 v142, 4, v142
    v_sub_u32 v143, v143, v142
    v_mul_u32_u24 v142, 3277, v141
    v_lshrrev_b32 v142, 16, v142
    v_add_u32 v141, v141, v142
    v_min_u32 v141, 335, v141
    v_mul_u32_u24 v142, 5440, v144
    v_lshl_add_u32 v141, v141, 2, v142
    v_add_u32 v141, 131072, v141
    v_add_u32 v148, s59, v0
    v_add_u32 v148, 512, v148
    v_cmp_lt_u32 vcc, 0x143, v148
    s_nop 1
    v_cndmask_b32_e64 v152, 0, 1, vcc
    v_mul_u32_u24 v149, 324, v152
    v_sub_u32 v149, v148, v149
    v_and_b32 v150, 3, v148
    v_lshlrev_b32 v151, 5, v148
    v_lshlrev_b32 v150, 4, v150
    v_sub_u32 v151, v151, v150
    v_mul_u32_u24 v150, 3277, v149
    v_lshrrev_b32 v150, 16, v150
    v_add_u32 v149, v149, v150
    v_min_u32 v149, 335, v149
    v_mul_u32_u24 v150, 5440, v152
    v_lshl_add_u32 v149, v149, 2, v150
    v_add_u32 v149, 131072, v149
    v_mov_b32 v18, 2146435072
    v_cmp_gt_u32 vcc, 0x288, v148
    s_nop 1
    v_cndmask_b32 v151, v18, v151, vcc
    s_lshl_b32 s73, s60, 2
    s_add_u32 s73, s73, s26
    s_lshl_b32 s73, s73, 5
    s_add_u32 s73, s73, s61
    s_and_b32 s59, s73, 3
    s_lshl_b32 s73, s73, 1
    s_sub_u32 s73, s73, s59
    s_lshl_b32 s73, s73, 4
    v_and_b32 v156, 1, v0
    v_lshlrev_b32 v157, 6, v156
    v_lshlrev_b32 v156, 3, v156
    s_lshl_b32 s59, s26, 4
    s_add_u32 s59, s59, 157600
    v_add_u32 v156, s59, v156
    s_lshl_b32 s74, s60, 5
    s_add_u32 s74, s74, s61
    s_lshl_b32 s74, s74, 4
    s_add_u32 s74, s74, 720896
    s_lshl_b32 s58, s26, 2
    s_add_u32 s58, s58, 157328
    v_mov_b32 v18, s58
    v_mov_b32 v19, 1
    ds_write_b32 v18, v19
    v_mov_b32 v22, 157328
    s_mov_b32 s30, 0
Lfw_28:
    ds_read_b128 v[18:21], v22
    s_waitcnt lgkmcnt(0)
    v_and_b32 v18, v18, v19
    v_and_b32 v20, v20, v21
    v_and_b32 v18, v18, v20
    s_nop 0
    v_readfirstlane_b32 s58, v18
    s_add_u32 s30, s30, 1
    s_cmp_ge_u32 s30, 320000
    s_cselect_b32 s58, 1, s58
    s_cmp_eq_u32 s58, 0
    s_cbranch_scc1 Lfw_28
    ds_read_b32 v136, v133 offset:0
    ds_read_b32 v137, v133 offset:1360
    ds_read_b32 v138, v133 offset:2720
    ds_read_b32 v139, v133 offset:4080
    ds_read_b32 v144, v141 offset:0
    ds_read_b32 v145, v141 offset:1360
    ds_read_b32 v146, v141 offset:2720
    ds_read_b32 v147, v141 offset:4080
    ds_read_b32 v152, v149 offset:0
    ds_read_b32 v153, v149 offset:1360
    ds_read_b32 v154, v149 offset:2720
    ds_read_b32 v155, v149 offset:4080
    ds_read_b32 v160, v156
    ds_read_b32 v162, v156 offset:4
    s_waitcnt vmcnt(0)
    v_readfirstlane_b32 s27, v24
    s_nop 0
    s_cmp_lg_u32 s27, 0
    s_cbranch_scc1 Lnok_29
    s_mov_b32 s30, 0
Lnlp_30:
    s_add_u32 s30, s30, 1
    s_cmp_lg_u32 s30, 200
    s_cbranch_scc1 Lnsk_31
    s_memrealtime s[58:59]
    s_waitcnt lgkmcnt(0)
    s_or_b32 s31, s58, 1
    v_mov_b32 v26, s31
    v_mov_b32 v27, 0
    buffer_atomic_cmpswap v[26:27], v25, s[36:39], 0 offen sc1
Lnsk_31:
    buffer_load_dword v24, v25, s[36:39], 0 offen sc1
    s_waitcnt vmcnt(0)
    v_readfirstlane_b32 s27, v24
    s_nop 0
    s_cmp_lg_u32 s27, 0
    s_cbranch_scc1 Lnok_29
    s_cmp_lt_u32 s30, 40000
    s_cbranch_scc1 Lnlp_30
Lnok_29:
    s_waitcnt lgkmcnt(0)
    v_mov_b32 v161, s27
    v_mov_b32 v163, s27
    s_mov_b64 exec, 3
    buffer_store_dwordx4 v[160:163], v157, s[48:51], s73 offen sc1
    s_mov_b64 exec, -1
    buffer_store_dwordx4 v[136:139], v135, s[48:51], s72 offen sc1
    buffer_store_dwordx4 v[144:147], v143, s[48:51], s72 offen sc1
    buffer_store_dwordx4 v[152:155], v151, s[48:51], s72 offen sc1
    s_waitcnt vmcnt(0)
    s_lshl_b32 s58, s26, 2
    s_add_u32 s58, s58, 157424
    v_mov_b32 v18, s58
    v_mov_b32 v19, 1
    ds_write_b32 v18, v19
    v_mov_b32 v22, 157424
    s_mov_b32 s30, 0
Lfw_32:
    ds_read_b128 v[18:21], v22
    s_waitcnt lgkmcnt(0)
    v_and_b32 v18, v18, v19
    v_and_b32 v20, v20, v21
    v_and_b32 v18, v18, v20
    s_nop 0
    v_readfirstlane_b32 s58, v18
    s_add_u32 s30, s30, 1
    s_cmp_ge_u32 s30, 320000
    s_cselect_b32 s58, 1, s58
    s_cmp_eq_u32 s58, 0
    s_cbranch_scc1 Lfw_32
    s_cmp_lg_u32 s26, 0
    s_cbranch_scc1 Ldone
    v_mov_b32 v18, s27
    v_mov_b32 v19, 0
    s_mov_b64 exec, 1
    buffer_store_dword v18, v19, s[48:51], s74 offen sc1
    s_mov_b64 exec, -1
    s_endpgm
Ldone:
    s_endpgm
.p2align 8
.type ctab,@object
ctab:
.long 0x3f80,0x3f80,0x3f80,0x3f80,0x3f80,0x3e483f7b,0x3ec43f6d,0x3f0e3f55
.long 0x3f80,0x3ec43f6d,0x3f353f35,0x3f6d3ec4,0x3f80,0x3f0e3f55,0x3f6d3ec4,0x3f7bbe48
.long 0x3f80,0x3f353f35,0x3f80248d,0x3f35bf35,0x3f80,0x3f553f0e,0x3f6dbec4,0x3e48bf7b
.long 0x3f80,0x3f6d3ec4,0x3f35bf35,0xbec4bf6d,0x3f80,0x3f7b3e48,0x3ec4bf6d,0xbf55bf0e
.long 0x3f80,0x3f80248d,0x250dbf80,0xbf80a554,0x3f80,0x3f7bbe48,0xbec4bf6d,0xbf553f0e
.long 0x3f80,0x3f6dbec4,0xbf35bf35,0xbec43f6d,0x3f80,0x3f55bf0e,0xbf6dbec4,0x3e483f7b
.long 0x3f80,0x3f35bf35,0xbf80a554,0x3f353f35,0x3f80,0x3f0ebf55,0xbf6d3ec4,0x3f7b3e48
.long 0x3f80,0x3ec4bf6d,0xbf353f35,0x3f6dbec4,0x3f80,0x3e48bf7b,0xbec43f6d,0x3f0ebf55
.long 0x3f80,0x250dbf80,0x3f80,0x250dbf80,0x3f80,0xbe48bf7b,0x3ec43f6d,0xbf0ebf55
.long 0x3f80,0xbec4bf6d,0x3f353f35,0xbf6dbec4,0x3f80,0xbf0ebf55,0x3f6d3ec4,0xbf7b3e48
.long 0x3f80,0xbf35bf35,0x3f80248d,0xbf353f35,0x3f80,0xbf55bf0e,0x3f6dbec4,0xbe483f7b
.long 0x3f80,0xbf6dbec4,0x3f35bf35,0x3ec43f6d,0x3f80,0xbf7bbe48,0x3ec4bf6d,0x3f553f0e
.long 0x3f80,0xbf80a554,0x250dbf80,0x3f80248d,0x3f80,0xbf7b3e48,0xbec4bf6d,0x3f55bf0e
.long 0x3f80,0xbf6d3ec4,0xbf35bf35,0x3ec4bf6d,0x3f80,0xbf553f0e,0xbf6dbec4,0xbe48bf7b
.long 0x3f80,0xbf353f35,0xbf80a554,0xbf35bf35,0x3f80,0xbf0e3f55,0xbf6d3ec4,0xbf7bbe48
.long 0x3f80,0xbec43f6d,0xbf353f35,0xbf6d3ec4,0x3f80,0xbe483f7b,0xbec43f6d,0xbf0e3f55
.long 0x3f80,0x3f80,0x3f80,0x3f80,0x3f353f35,0x3f553f0e,0x3f6d3ec4,0x3f7b3e48
.long 0x3f80248d,0x3f6dbec4,0x3f35bf35,0x3ec4bf6d,0x3f35bf35,0x3e48bf7b,0xbec4bf6d,0xbf55bf0e
.long 0x250dbf80,0xbf35bf35,0xbf80a554,0xbf353f35,0xbf35bf35,0xbf7b3e48,0xbec43f6d,0x3f0e3f55
.long 0xbf80a554,0xbec43f6d,0x3f353f35,0x3f6dbec4,0xbf353f35,0x3f0e3f55,0x3f6dbec4,0xbe48bf7b
.long 0x3f80,0x3f80248d,0x250dbf80,0xbf80a554,0x3f353f35,0x3f0ebf55,0xbf6dbec4,0xbe483f7b
.long 0x3f80248d,0xbec4bf6d,0xbf353f35,0x3f6d3ec4,0x3f35bf35,0xbf7bbe48,0x3ec43f6d,0x3f0ebf55
.long 0x250dbf80,0xbf353f35,0x3f80248d,0xbf35bf35,0xbf35bf35,0x3e483f7b,0x3ec4bf6d,0xbf553f0e
.long 0xbf80a554,0x3f6d3ec4,0xbf35bf35,0x3ec43f6d,0xbf353f35,0x3f55bf0e,0xbf6d3ec4,0x3f7bbe48
.long 0x3f80,0x250dbf80,0x3f80,0x250dbf80,0x3f353f35,0xbf55bf0e,0x3f6d3ec4,0xbf7bbe48
.long 0x3f80248d,0xbf6d3ec4,0x3f35bf35,0xbec43f6d,0x3f35bf35,0xbe483f7b,0xbec4bf6d,0x3f553f0e
.long 0x250dbf80,0x3f353f35,0xbf80a554,0x3f35bf35,0xbf35bf35,0x3f7bbe48,0xbec43f6d,0xbf0ebf55
.long 0xbf80a554,0x3ec4bf6d,0x3f353f35,0xbf6d3ec4,0xbf353f35,0xbf0ebf55,0x3f6dbec4,0x3e483f7b
.long 0x3f80,0xbf80a554,0x250dbf80,0x3f80248d,0x3f353f35,0xbf0e3f55,0xbf6dbec4,0x3e48bf7b
.long 0x3f80248d,0x3ec43f6d,0xbf353f35,0xbf6dbec4,0x3f35bf35,0x3f7b3e48,0x3ec43f6d,0xbf0e3f55
.long 0x250dbf80,0x3f35bf35,0x3f80248d,0x3f353f35,0xbf35bf35,0xbe48bf7b,0x3ec4bf6d,0x3f55bf0e
.long 0xbf80a554,0xbf6dbec4,0xbf35bf35,0xbec4bf6d,0xbf353f35,0xbf553f0e,0xbf6d3ec4,0xbf7b3e48
.long 0x3f80,0x3f80,0x3f80,0x3f80,0x3f80248d,0x3f7bbe48,0x3f6dbec4,0x3f55bf0e
.long 0x250dbf80,0xbec4bf6d,0xbf35bf35,0xbf6dbec4,0xbf80a554,0xbf553f0e,0xbec43f6d,0x3e483f7b
.long 0x3f80,0x3f353f35,0x3f80248d,0x3f35bf35,0x3f80248d,0x3f0ebf55,0xbec4bf6d,0xbf7bbe48
.long 0x250dbf80,0xbf6dbec4,0xbf353f35,0x3ec43f6d,0xbf80a554,0xbe483f7b,0x3f6d3ec4,0x3f0ebf55
.long 0x3f80,0x3f80248d,0x250dbf80,0xbf80a554,0x3f80248d,0xbe48bf7b,0xbf6d3ec4,0x3f0e3f55
.long 0x250dbf80,0xbf6d3ec4,0x3f353f35,0x3ec4bf6d,0xbf80a554,0x3f0e3f55,0x3ec4bf6d,0xbf7b3e48
.long 0x3f80,0x3f35bf35,0xbf80a554,0x3f353f35,0x3f80248d,0xbf55bf0e,0x3ec43f6d,0x3e48bf7b
.long 0x250dbf80,0xbec43f6d,0x3f35bf35,0xbf6d3ec4,0xbf80a554,0x3f7b3e48,0xbf6dbec4,0x3f553f0e
.long 0x3f80,0x250dbf80,0x3f80,0x250dbf80,0x3f80248d,0xbf7b3e48,0x3f6dbec4,0xbf553f0e
.long 0x250dbf80,0x3ec43f6d,0xbf35bf35,0x3f6d3ec4,0xbf80a554,0x3f55bf0e,0xbec43f6d,0xbe48bf7b
.long 0x3f80,0xbf35bf35,0x3f80248d,0xbf353f35,0x3f80248d,0xbf0e3f55,0xbec4bf6d,0x3f7b3e48
.long 0x250dbf80,0x3f6d3ec4,0xbf353f35,0xbec4bf6d,0xbf80a554,0x3e48bf7b,0x3f6d3ec4,0xbf0e3f55
.long 0x3f80,0xbf80a554,0x250dbf80,0x3f80248d,0x3f80248d,0x3e483f7b,0xbf6d3ec4,0xbf0ebf55
.long 0x250dbf80,0x3f6dbec4,0x3f353f35,0xbec43f6d,0xbf80a554,0xbf0ebf55,0x3ec4bf6d,0x3f7bbe48
.long 0x3f80,0xbf353f35,0xbf80a554,0xbf35bf35,0x3f80248d,0x3f553f0e,0x3ec43f6d,0xbe483f7b
.long 0x250dbf80,0x3ec4bf6d,0x3f35bf35,0x3f6dbec4,0xbf80a554,0xbf7bbe48,0xbf6dbec4,0xbf55bf0e
.long 0x3f80,0x3f80,0x3f80,0x3f80,0x3f35bf35,0x3f0ebf55,0x3ec4bf6d,0x3e48bf7b
.long 0xbf80a554,0xbf6d3ec4,0xbf353f35,0xbec43f6d,0x3f353f35,0x3f7b3e48,0x3f6dbec4,0x3f0ebf55
.long 0x250dbf80,0xbf35bf35,0xbf80a554,0xbf353f35,0xbf353f35,0x3e483f7b,0x3f6d3ec4,0x3f55bf0e
.long 0x3f80248d,0x3ec4bf6d,0xbf35bf35,0xbf6d3ec4,0xbf35bf35,0xbf553f0e,0x3ec43f6d,0x3f7bbe48
.long 0x3f80,0x3f80248d,0x250dbf80,0xbf80a554,0x3f35bf35,0xbf55bf0e,0xbec43f6d,0x3f7b3e48
.long 0xbf80a554,0x3ec43f6d,0x3f35bf35,0xbf6dbec4,0x3f353f35,0x3e48bf7b,0xbf6d3ec4,0x3f553f0e
.long 0x250dbf80,0xbf353f35,0x3f80248d,0xbf35bf35,0xbf353f35,0x3f7bbe48,0xbf6dbec4,0x3f0e3f55
.long 0x3f80248d,0xbf6dbec4,0x3f353f35,0xbec4bf6d,0xbf35bf35,0x3f0e3f55,0xbec4bf6d,0x3e483f7b
.long 0x3f80,0x250dbf80,0x3f80,0x250dbf80,0x3f35bf35,0xbf0e3f55,0x3ec4bf6d,0xbe483f7b
.long 0xbf80a554,0x3f6dbec4,0xbf353f35,0x3ec4bf6d,0x3f353f35,0xbf7bbe48,0x3f6dbec4,0xbf0e3f55
.long 0x250dbf80,0x3f353f35,0xbf80a554,0x3f35bf35,0xbf353f35,0xbe48bf7b,0x3f6d3ec4,0xbf553f0e
.long 0x3f80248d,0xbec43f6d,0xbf35bf35,0x3f6dbec4,0xbf35bf35,0x3f55bf0e,0x3ec43f6d,0xbf7b3e48
.long 0x3f80,0xbf80a554,0x250dbf80,0x3f80248d,0x3f35bf35,0x3f553f0e,0xbec43f6d,0xbf7bbe48
.long 0xbf80a554,0xbec4bf6d,0x3f35bf35,0x3f6d3ec4,0x3f353f35,0xbe483f7b,0xbf6d3ec4,0xbf55bf0e
.long 0x250dbf80,0x3f35bf35,0x3f80248d,0x3f353f35,0xbf353f35,0xbf7b3e48,0xbf6dbec4,0xbf0ebf55
.long 0x3f80248d,0x3f6d3ec4,0x3f353f35,0x3ec43f6d,0xbf35bf35,0xbf0ebf55,0xbec4bf6d,0xbe48bf7b
.long 0x80003f80,0x80003f80,0x80003f80,0x80003f80,0xa50dbf80,0x3e48bf7b,0x3ec4bf6d,0x3f0ebf55
.long 0x80003f80,0xbec43f6d,0xbf353f35,0xbf6d3ec4,0xa50dbf80,0x3f0ebf55,0x3f6dbec4,0x3f7b3e48
.long 0x80003f80,0xbf353f35,0xbf80248d,0xbf35bf35,0xa50dbf80,0x3f55bf0e,0x3f6d3ec4,0x3e483f7b
.long 0x80003f80,0xbf6d3ec4,0xbf35bf35,0x3ec4bf6d,0xa50dbf80,0x3f7bbe48,0x3ec43f6d,0xbf553f0e
.long 0x80003f80,0xbf80248d,0xa50dbf80,0x3f80a554,0xa50dbf80,0x3f7b3e48,0xbec43f6d,0xbf55bf0e
.long 0x80003f80,0xbf6dbec4,0x3f35bf35,0x3ec43f6d,0xa50dbf80,0x3f553f0e,0xbf6d3ec4,0x3e48bf7b
.long 0x80003f80,0xbf35bf35,0x3f80a554,0xbf353f35,0xa50dbf80,0x3f0e3f55,0xbf6dbec4,0x3f7bbe48
.long 0x80003f80,0xbec4bf6d,0x3f353f35,0xbf6dbec4,0xa50dbf80,0x3e483f7b,0xbec4bf6d,0x3f0e3f55
.long 0x80003f80,0xa50dbf80,0x80003f80,0xa50dbf80,0xa50dbf80,0xbe483f7b,0x3ec4bf6d,0xbf0e3f55
.long 0x80003f80,0x3ec4bf6d,0xbf353f35,0x3f6dbec4,0xa50dbf80,0xbf0e3f55,0x3f6dbec4,0xbf7bbe48
.long 0x80003f80,0x3f35bf35,0xbf80248d,0x3f353f35,0xa50dbf80,0xbf553f0e,0x3f6d3ec4,0xbe48bf7b
.long 0x80003f80,0x3f6dbec4,0xbf35bf35,0xbec43f6d,0xa50dbf80,0xbf7b3e48,0x3ec43f6d,0x3f55bf0e
.long 0x80003f80,0x3f80a554,0xa50dbf80,0xbf80248d,0xa50dbf80,0xbf7bbe48,0xbec43f6d,0x3f553f0e
.long 0x80003f80,0x3f6d3ec4,0x3f35bf35,0xbec4bf6d,0xa50dbf80,0xbf55bf0e,0xbf6d3ec4,0xbe483f7b
.long 0x80003f80,0x3f353f35,0x3f80a554,0x3f35bf35,0xa50dbf80,0xbf0ebf55,0xbf6dbec4,0xbf7b3e48
.long 0x80003f80,0x3ec43f6d,0x3f353f35,0x3f6d3ec4,0xa50dbf80,0xbe48bf7b,0xbec4bf6d,0xbf0ebf55
.long 0x80003f80,0x80003f80,0x80003f80,0x80003f80,0x3f35bf35,0x3f55bf0e,0x3f6dbec4,0x3f7bbe48
.long 0xbf80248d,0xbf6dbec4,0xbf35bf35,0xbec4bf6d,0x3f353f35,0x3e483f7b,0xbec43f6d,0xbf553f0e
.long 0xa50dbf80,0x3f35bf35,0x3f80a554,0x3f353f35,0xbf353f35,0xbf7bbe48,0xbec4bf6d,0x3f0ebf55
.long 0x3f80a554,0x3ec43f6d,0xbf353f35,0xbf6dbec4,0xbf35bf35,0x3f0ebf55,0x3f6d3ec4,0xbe483f7b
.long 0x80003f80,0xbf80248d,0xa50dbf80,0x3f80a554,0x3f35bf35,0x3f0e3f55,0xbf6d3ec4,0xbe48bf7b
.long 0xbf80248d,0x3ec4bf6d,0x3f353f35,0xbf6d3ec4,0x3f353f35,0xbf7b3e48,0x3ec4bf6d,0x3f0e3f55
.long 0xa50dbf80,0x3f353f35,0xbf80248d,0x3f35bf35,0xbf353f35,0x3e48bf7b,0x3ec43f6d,0xbf55bf0e
.long 0x3f80a554,0xbf6d3ec4,0x3f35bf35,0xbec43f6d,0xbf35bf35,0x3f553f0e,0xbf6dbec4,0x3f7b3e48
.long 0x80003f80,0xa50dbf80,0x80003f80,0xa50dbf80,0x3f35bf35,0xbf553f0e,0x3f6dbec4,0xbf7b3e48
.long 0xbf80248d,0x3f6d3ec4,0xbf35bf35,0x3ec43f6d,0x3f353f35,0xbe48bf7b,0xbec43f6d,0x3f55bf0e
.long 0xa50dbf80,0xbf353f35,0x3f80a554,0xbf35bf35,0xbf353f35,0x3f7b3e48,0xbec4bf6d,0xbf0e3f55
.long 0x3f80a554,0xbec4bf6d,0xbf353f35,0x3f6d3ec4,0xbf35bf35,0xbf0e3f55,0x3f6d3ec4,0x3e48bf7b
.long 0x80003f80,0x3f80a554,0xa50dbf80,0xbf80248d,0x3f35bf35,0xbf0ebf55,0xbf6d3ec4,0x3e483f7b
.long 0xbf80248d,0xbec43f6d,0x3f353f35,0x3f6dbec4,0x3f353f35,0x3f7bbe48,0x3ec4bf6d,0xbf0ebf55
.long 0xa50dbf80,0xbf35bf35,0xbf80248d,0xbf353f35,0xbf353f35,0xbe483f7b,0x3ec43f6d,0x3f553f0e
.long 0x3f80a554,0x3f6dbec4,0x3f35bf35,0x3ec4bf6d,0xbf35bf35,0xbf55bf0e,0xbf6dbec4,0xbf7bbe48
.long 0x80003f80,0x80003f80,0x80003f80,0x80003f80,0x3f80a554,0x3f7b3e48,0x3f6d3ec4,0x3f553f0e
.long 0xa50dbf80,0x3ec4bf6d,0x3f35bf35,0x3f6dbec4,0xbf80248d,0xbf55bf0e,0xbec4bf6d,0x3e48bf7b
.long 0x80003f80,0xbf353f35,0xbf80248d,0xbf35bf35,0x3f80a554,0x3f0e3f55,0xbec43f6d,0xbf7b3e48
.long 0xa50dbf80,0x3f6dbec4,0x3f353f35,0xbec43f6d,0xbf80248d,0xbe48bf7b,0x3f6dbec4,0x3f0e3f55
.long 0x80003f80,0xbf80248d,0xa50dbf80,0x3f80a554,0x3f80a554,0xbe483f7b,0xbf6dbec4,0x3f0ebf55
.long 0xa50dbf80,0x3f6d3ec4,0xbf353f35,0xbec4bf6d,0xbf80248d,0x3f0ebf55,0x3ec43f6d,0xbf7bbe48
.long 0x80003f80,0xbf35bf35,0x3f80a554,0xbf353f35,0x3f80a554,0xbf553f0e,0x3ec4bf6d,0x3e483f7b
.long 0xa50dbf80,0x3ec43f6d,0xbf35bf35,0x3f6d3ec4,0xbf80248d,0x3f7bbe48,0xbf6d3ec4,0x3f55bf0e
.long 0x80003f80,0xa50dbf80,0x80003f80,0xa50dbf80,0x3f80a554,0xbf7bbe48,0x3f6d3ec4,0xbf55bf0e
.long 0xa50dbf80,0xbec43f6d,0x3f35bf35,0xbf6d3ec4,0xbf80248d,0x3f553f0e,0xbec4bf6d,0xbe483f7b
.long 0x80003f80,0x3f35bf35,0xbf80248d,0x3f353f35,0x3f80a554,0xbf0ebf55,0xbec43f6d,0x3f7bbe48
.long 0xa50dbf80,0xbf6d3ec4,0x3f353f35,0x3ec4bf6d,0xbf80248d,0x3e483f7b,0x3f6dbec4,0xbf0ebf55
.long 0x80003f80,0x3f80a554,0xa50dbf80,0xbf80248d,0x3f80a554,0x3e48bf7b,0xbf6dbec4,0xbf0e3f55
.long 0xa50dbf80,0xbf6dbec4,0xbf353f35,0x3ec43f6d,0xbf80248d,0xbf0e3f55,0x3ec43f6d,0x3f7b3e48
.long 0x80003f80,0x3f353f35,0x3f80a554,0x3f35bf35,0x3f80a554,0x3f55bf0e,0x3ec4bf6d,0xbe48bf7b
.long 0xa50dbf80,0xbec4bf6d,0xbf35bf35,0xbf6dbec4,0xbf80248d,0xbf7b3e48,0xbf6d3ec4,0xbf553f0e
.long 0x80003f80,0x80003f80,0x80003f80,0x80003f80,0x3f353f35,0x3f0e3f55,0x3ec43f6d,0x3e483f7b
.long 0x3f80a554,0x3f6d3ec4,0x3f353f35,0x3ec43f6d,0x3f35bf35,0x3f7bbe48,0x3f6d3ec4,0x3f0e3f55
.long 0xa50dbf80,0x3f35bf35,0x3f80a554,0x3f353f35,0xbf35bf35,0x3e48bf7b,0x3f6dbec4,0x3f553f0e
.long 0xbf80248d,0xbec4bf6d,0x3f35bf35,0x3f6d3ec4,0xbf353f35,0xbf55bf0e,0x3ec4bf6d,0x3f7b3e48
.long 0x80003f80,0xbf80248d,0xa50dbf80,0x3f80a554,0x3f353f35,0xbf553f0e,0xbec4bf6d,0x3f7bbe48
.long 0x3f80a554,0xbec43f6d,0xbf35bf35,0x3f6dbec4,0x3f35bf35,0x3e483f7b,0xbf6dbec4,0x3f55bf0e
.long 0xa50dbf80,0x3f353f35,0xbf80248d,0x3f35bf35,0xbf35bf35,0x3f7b3e48,0xbf6d3ec4,0x3f0ebf55
.long 0xbf80248d,0x3f6dbec4,0xbf353f35,0x3ec4bf6d,0xbf353f35,0x3f0ebf55,0xbec43f6d,0x3e48bf7b
.long 0x80003f80,0xa50dbf80,0x80003f80,0xa50dbf80,0x3f353f35,0xbf0ebf55,0x3ec43f6d,0xbe48bf7b
.long 0x3f80a554,0xbf6dbec4,0x3f353f35,0xbec4bf6d,0x3f35bf35,0xbf7b3e48,0x3f6d3ec4,0xbf0ebf55
.long 0xa50dbf80,0xbf353f35,0x3f80a554,0xbf35bf35,0xbf35bf35,0xbe483f7b,0x3f6dbec4,0xbf55bf0e
.long 0xbf80248d,0x3ec43f6d,0x3f35bf35,0xbf6dbec4,0xbf353f35,0x3f553f0e,0x3ec4bf6d,0xbf7bbe48
.long 0x80003f80,0x3f80a554,0xa50dbf80,0xbf80248d,0x3f353f35,0x3f55bf0e,0xbec4bf6d,0xbf7b3e48
.long 0x3f80a554,0x3ec4bf6d,0xbf35bf35,0xbf6d3ec4,0x3f35bf35,0xbe48bf7b,0xbf6dbec4,0xbf553f0e
.long 0xa50dbf80,0xbf35bf35,0xbf80248d,0xbf353f35,0xbf35bf35,0xbf7bbe48,0xbf6d3ec4,0xbf0e3f55
.long 0xbf80248d,0xbf6d3ec4,0xbf353f35,0xbec43f6d,0xbf353f35,0xbf0e3f55,0xbec43f6d,0xbe483f7b
.long 0x3f808000,0x3f808000,0x3f808000,0x3f808000,0x3f808000,0x3f7bbe48,0x3f6dbec4,0x3f55bf0e
.long 0x3f808000,0x3f6dbec4,0x3f35bf35,0x3ec4bf6d,0x3f808000,0x3f55bf0e,0x3ec4bf6d,0xbe48bf7b
.long 0x3f808000,0x3f35bf35,0x248dbf80,0xbf35bf35,0x3f808000,0x3f0ebf55,0xbec4bf6d,0xbf7bbe48
.long 0x3f808000,0x3ec4bf6d,0xbf35bf35,0xbf6d3ec4,0x3f808000,0x3e48bf7b,0xbf6dbec4,0xbf0e3f55
.long 0x3f808000,0x248dbf80,0xbf80a50d,0xa5543f80,0x3f808000,0xbe48bf7b,0xbf6d3ec4,0x3f0e3f55
.long 0x3f808000,0xbec4bf6d,0xbf353f35,0x3f6d3ec4,0x3f808000,0xbf0ebf55,0xbec43f6d,0x3f7bbe48
.long 0x3f808000,0xbf35bf35,0xa5543f80,0x3f35bf35,0x3f808000,0xbf55bf0e,0x3ec43f6d,0x3e48bf7b
.long 0x3f808000,0xbf6dbec4,0x3f353f35,0xbec4bf6d,0x3f808000,0xbf7bbe48,0x3f6d3ec4,0xbf55bf0e
.long 0x3f808000,0xbf80a50d,0x3f808000,0xbf80a50d,0x3f808000,0xbf7b3e48,0x3f6dbec4,0xbf553f0e
.long 0x3f808000,0xbf6d3ec4,0x3f35bf35,0xbec43f6d,0x3f808000,0xbf553f0e,0x3ec4bf6d,0x3e483f7b
.long 0x3f808000,0xbf353f35,0x248dbf80,0x3f353f35,0x3f808000,0xbf0e3f55,0xbec4bf6d,0x3f7b3e48
.long 0x3f808000,0xbec43f6d,0xbf35bf35,0x3f6dbec4,0x3f808000,0xbe483f7b,0xbf6dbec4,0x3f0ebf55
.long 0x3f808000,0xa5543f80,0xbf80a50d,0x248dbf80,0x3f808000,0x3e483f7b,0xbf6d3ec4,0xbf0ebf55
.long 0x3f808000,0x3ec43f6d,0xbf353f35,0xbf6dbec4,0x3f808000,0x3f0e3f55,0xbec43f6d,0xbf7b3e48
.long 0x3f808000,0x3f353f35,0xa5543f80,0xbf353f35,0x3f808000,0x3f553f0e,0x3ec43f6d,0xbe483f7b
.long 0x3f808000,0x3f6d3ec4,0x3f353f35,0x3ec43f6d,0x3f808000,0x3f7b3e48,0x3f6d3ec4,0x3f553f0e
.long 0x3f808000,0x3f808000,0x3f808000,0x3f808000,0x3f35bf35,0x3f0ebf55,0x3ec4bf6d,0x3e48bf7b
.long 0x248dbf80,0xbec4bf6d,0xbf35bf35,0xbf6dbec4,0xbf35bf35,0xbf7bbe48,0xbf6d3ec4,0xbf0e3f55
.long 0xbf80a50d,0xbf353f35,0xa5543f80,0x3f353f35,0xbf353f35,0x3e483f7b,0x3f6d3ec4,0x3f55bf0e
.long 0xa5543f80,0x3f6d3ec4,0x3f35bf35,0xbec4bf6d,0x3f353f35,0x3f55bf0e,0xbec4bf6d,0xbf7b3e48
.long 0x3f808000,0x248dbf80,0xbf80a50d,0xa5543f80,0x3f35bf35,0xbf55bf0e,0xbec43f6d,0x3f7b3e48
.long 0x248dbf80,0xbf6d3ec4,0x3f353f35,0x3ec4bf6d,0xbf35bf35,0xbe483f7b,0x3f6dbec4,0xbf55bf0e
.long 0xbf80a50d,0x3f353f35,0x248dbf80,0xbf353f35,0xbf353f35,0x3f7bbe48,0xbf6dbec4,0x3f0e3f55
.long 0xa5543f80,0x3ec4bf6d,0xbf353f35,0x3f6dbec4,0x3f353f35,0xbf0ebf55,0x3ec43f6d,0xbe48bf7b
.long 0x3f808000,0xbf80a50d,0x3f808000,0xbf80a50d,0x3f35bf35,0xbf0e3f55,0x3ec4bf6d,0xbe483f7b
.long 0x248dbf80,0x3ec43f6d,0xbf35bf35,0x3f6d3ec4,0xbf35bf35,0x3f7b3e48,0xbf6d3ec4,0x3f0ebf55
.long 0xbf80a50d,0x3f35bf35,0xa5543f80,0xbf35bf35,0xbf353f35,0xbe48bf7b,0x3f6d3ec4,0xbf553f0e
.long 0xa5543f80,0xbf6dbec4,0x3f35bf35,0x3ec43f6d,0x3f353f35,0xbf553f0e,0xbec4bf6d,0x3f7bbe48
.long 0x3f808000,0xa5543f80,0xbf80a50d,0x248dbf80,0x3f35bf35,0x3f553f0e,0xbec43f6d,0xbf7bbe48
.long 0x248dbf80,0x3f6dbec4,0x3f353f35,0xbec43f6d,0xbf35bf35,0x3e48bf7b,0x3f6dbec4,0x3f553f0e
.long 0xbf80a50d,0xbf35bf35,0x248dbf80,0x3f35bf35,0xbf353f35,0xbf7b3e48,0xbf6dbec4,0xbf0ebf55
.long 0xa5543f80,0xbec43f6d,0xbf353f35,0xbf6d3ec4,0x3f353f35,0x3f0e3f55,0x3ec43f6d,0x3e483f7b
.long 0x3f808000,0x3f808000,0x3f808000,0x3f808000,0x248dbf80,0xbe48bf7b,0xbec4bf6d,0xbf0ebf55
.long 0xbf80a50d,0xbf6d3ec4,0xbf353f35,0xbec43f6d,0xa5543f80,0x3f0e3f55,0x3f6d3ec4,0x3f7bbe48
.long 0x3f808000,0x3f35bf35,0x248dbf80,0xbf35bf35,0x248dbf80,0xbf55bf0e,0xbf6d3ec4,0xbe483f7b
.long 0xbf80a50d,0xbec43f6d,0x3f353f35,0x3f6dbec4,0xa5543f80,0x3f7b3e48,0x3ec4bf6d,0xbf55bf0e
.long 0x3f808000,0x248dbf80,0xbf80a50d,0xa5543f80,0x248dbf80,0xbf7b3e48,0x3ec43f6d,0x3f55bf0e
.long 0xbf80a50d,0x3ec43f6d,0x3f35bf35,0xbf6dbec4,0xa5543f80,0x3f55bf0e,0xbf6dbec4,0x3e483f7b
.long 0x3f808000,0xbf35bf35,0xa5543f80,0x3f35bf35,0x248dbf80,0xbf0e3f55,0x3f6dbec4,0xbf7bbe48
.long 0xbf80a50d,0x3f6d3ec4,0xbf35bf35,0x3ec43f6d,0xa5543f80,0x3e48bf7b,0xbec43f6d,0x3f0ebf55
.long 0x3f808000,0xbf80a50d,0x3f808000,0xbf80a50d,0x248dbf80,0x3e483f7b,0xbec4bf6d,0x3f0e3f55
.long 0xbf80a50d,0x3f6dbec4,0xbf353f35,0x3ec4bf6d,0xa5543f80,0xbf0ebf55,0x3f6d3ec4,0xbf7b3e48
.long 0x3f808000,0xbf353f35,0x248dbf80,0x3f353f35,0x248dbf80,0x3f553f0e,0xbf6d3ec4,0x3e48bf7b
.long 0xbf80a50d,0x3ec4bf6d,0x3f353f35,0xbf6d3ec4,0xa5543f80,0xbf7bbe48,0x3ec4bf6d,0x3f553f0e
.long 0x3f808000,0xa5543f80,0xbf80a50d,0x248dbf80,0x248dbf80,0x3f7bbe48,0x3ec43f6d,0xbf553f0e
.long 0xbf80a50d,0xbec4bf6d,0x3f35bf35,0x3f6d3ec4,0xa5543f80,0xbf553f0e,0xbf6dbec4,0xbe48bf7b
.long 0x3f808000,0x3f353f35,0xa5543f80,0xbf353f35,0x248dbf80,0x3f0ebf55,0x3f6dbec4,0x3f7b3e48
.long 0xbf80a50d,0xbf6dbec4,0xbf35bf35,0xbec4bf6d,0xa5543f80,0xbe483f7b,0xbec43f6d,0xbf0e3f55
.long 0x3f808000,0x3f808000,0x3f808000,0x3f808000,0xbf35bf35,0xbf55bf0e,0xbf6dbec4,0xbf7bbe48
.long 0xa5543f80,0x3ec43f6d,0x3f353f35,0x3f6d3ec4,0x3f35bf35,0x3e48bf7b,0xbec4bf6d,0xbf55bf0e
.long 0xbf80a50d,0xbf353f35,0xa5543f80,0x3f353f35,0x3f353f35,0x3f7bbe48,0x3ec4bf6d,0xbf0ebf55
.long 0x248dbf80,0xbf6dbec4,0xbf353f35,0x3ec43f6d,0xbf353f35,0x3f0e3f55,0x3f6dbec4,0xbe48bf7b
.long 0x3f808000,0x248dbf80,0xbf80a50d,0xa5543f80,0xbf35bf35,0xbf0e3f55,0x3f6d3ec4,0x3e48bf7b
.long 0xa5543f80,0x3f6dbec4,0xbf35bf35,0xbec43f6d,0x3f35bf35,0xbf7bbe48,0x3ec43f6d,0x3f0ebf55
.long 0xbf80a50d,0x3f353f35,0x248dbf80,0xbf353f35,0x3f353f35,0xbe48bf7b,0xbec43f6d,0x3f55bf0e
.long 0x248dbf80,0xbec43f6d,0x3f35bf35,0xbf6d3ec4,0xbf353f35,0x3f55bf0e,0xbf6d3ec4,0x3f7bbe48
.long 0x3f808000,0xbf80a50d,0x3f808000,0xbf80a50d,0xbf35bf35,0x3f553f0e,0xbf6dbec4,0x3f7b3e48
.long 0xa5543f80,0xbec4bf6d,0x3f353f35,0xbf6dbec4,0x3f35bf35,0xbe483f7b,0xbec4bf6d,0x3f553f0e
.long 0xbf80a50d,0x3f35bf35,0xa5543f80,0xbf35bf35,0x3f353f35,0xbf7b3e48,0x3ec4bf6d,0x3f0e3f55
.long 0x248dbf80,0x3f6d3ec4,0xbf353f35,0xbec4bf6d,0xbf353f35,0xbf0ebf55,0x3f6dbec4,0x3e483f7b
.long 0x3f808000,0xa5543f80,0xbf80a50d,0x248dbf80,0xbf35bf35,0x3f0ebf55,0x3f6d3ec4,0xbe483f7b
.long 0xa5543f80,0xbf6d3ec4,0xbf35bf35,0x3ec4bf6d,0x3f35bf35,0x3f7b3e48,0x3ec43f6d,0xbf0e3f55
.long 0xbf80a50d,0xbf35bf35,0x248dbf80,0x3f35bf35,0x3f353f35,0x3e483f7b,0xbec43f6d,0xbf553f0e
.long 0x248dbf80,0x3ec4bf6d,0x3f35bf35,0x3f6dbec4,0xbf353f35,0xbf553f0e,0xbf6d3ec4,0xbf7b3e48
.long 0xbf808000,0xbf808000,0xbf808000,0xbf808000,0x3f80a50d,0x3f7b3e48,0x3f6d3ec4,0x3f553f0e
.long 0xbf808000,0xbf6dbec4,0xbf35bf35,0xbec4bf6d,0x3f80a50d,0x3f553f0e,0x3ec43f6d,0xbe483f7b
.long 0xbf808000,0xbf35bf35,0xa48dbf80,0x3f35bf35,0x3f80a50d,0x3f0e3f55,0xbec43f6d,0xbf7b3e48
.long 0xbf808000,0xbec4bf6d,0x3f35bf35,0x3f6d3ec4,0x3f80a50d,0x3e483f7b,0xbf6d3ec4,0xbf0ebf55
.long 0xbf808000,0xa48dbf80,0x3f80a50d,0x25543f80,0x3f80a50d,0xbe483f7b,0xbf6dbec4,0x3f0ebf55
.long 0xbf808000,0x3ec4bf6d,0x3f353f35,0xbf6d3ec4,0x3f80a50d,0xbf0e3f55,0xbec4bf6d,0x3f7b3e48
.long 0xbf808000,0x3f35bf35,0x25543f80,0xbf35bf35,0x3f80a50d,0xbf553f0e,0x3ec4bf6d,0x3e483f7b
.long 0xbf808000,0x3f6dbec4,0xbf353f35,0x3ec4bf6d,0x3f80a50d,0xbf7b3e48,0x3f6dbec4,0xbf553f0e
.long 0xbf808000,0x3f80a50d,0xbf808000,0x3f80a50d,0x3f80a50d,0xbf7bbe48,0x3f6d3ec4,0xbf55bf0e
.long 0xbf808000,0x3f6d3ec4,0xbf35bf35,0x3ec43f6d,0x3f80a50d,0xbf55bf0e,0x3ec43f6d,0x3e48bf7b
.long 0xbf808000,0x3f353f35,0xa48dbf80,0xbf353f35,0x3f80a50d,0xbf0ebf55,0xbec43f6d,0x3f7bbe48
.long 0xbf808000,0x3ec43f6d,0x3f35bf35,0xbf6dbec4,0x3f80a50d,0xbe48bf7b,0xbf6d3ec4,0x3f0e3f55
.long 0xbf808000,0x25543f80,0x3f80a50d,0xa48dbf80,0x3f80a50d,0x3e48bf7b,0xbf6dbec4,0xbf0e3f55
.long 0xbf808000,0xbec43f6d,0x3f353f35,0x3f6dbec4,0x3f80a50d,0x3f0ebf55,0xbec4bf6d,0xbf7bbe48
.long 0xbf808000,0xbf353f35,0x25543f80,0x3f353f35,0x3f80a50d,0x3f55bf0e,0x3ec4bf6d,0xbe48bf7b
.long 0xbf808000,0xbf6d3ec4,0xbf353f35,0xbec43f6d,0x3f80a50d,0x3f7bbe48,0x3f6dbec4,0x3f55bf0e
.long 0xbf808000,0xbf808000,0xbf808000,0xbf808000,0x3f353f35,0x3f0e3f55,0x3ec43f6d,0x3e483f7b
.long 0xa48dbf80,0x3ec4bf6d,0x3f35bf35,0x3f6dbec4,0xbf353f35,0xbf7b3e48,0xbf6dbec4,0xbf0ebf55
.long 0x3f80a50d,0x3f353f35,0x25543f80,0xbf353f35,0xbf35bf35,0x3e48bf7b,0x3f6dbec4,0x3f553f0e
.long 0x25543f80,0xbf6d3ec4,0xbf35bf35,0x3ec4bf6d,0x3f35bf35,0x3f553f0e,0xbec43f6d,0xbf7bbe48
.long 0xbf808000,0xa48dbf80,0x3f80a50d,0x25543f80,0x3f353f35,0xbf553f0e,0xbec4bf6d,0x3f7bbe48
.long 0xa48dbf80,0x3f6d3ec4,0xbf353f35,0xbec4bf6d,0xbf353f35,0xbe48bf7b,0x3f6d3ec4,0xbf553f0e
.long 0x3f80a50d,0xbf353f35,0xa48dbf80,0x3f353f35,0xbf35bf35,0x3f7b3e48,0xbf6d3ec4,0x3f0ebf55
.long 0x25543f80,0xbec4bf6d,0x3f353f35,0xbf6dbec4,0x3f35bf35,0xbf0e3f55,0x3ec4bf6d,0xbe483f7b
.long 0xbf808000,0x3f80a50d,0xbf808000,0x3f80a50d,0x3f353f35,0xbf0ebf55,0x3ec43f6d,0xbe48bf7b
.long 0xa48dbf80,0xbec43f6d,0x3f35bf35,0xbf6d3ec4,0xbf353f35,0x3f7bbe48,0xbf6dbec4,0x3f0e3f55
.long 0x3f80a50d,0xbf35bf35,0x25543f80,0x3f35bf35,0xbf35bf35,0xbe483f7b,0x3f6dbec4,0xbf55bf0e
.long 0x25543f80,0x3f6dbec4,0xbf35bf35,0xbec43f6d,0x3f35bf35,0xbf55bf0e,0xbec43f6d,0x3f7b3e48
.long 0xbf808000,0x25543f80,0x3f80a50d,0xa48dbf80,0x3f353f35,0x3f55bf0e,0xbec4bf6d,0xbf7b3e48
.long 0xa48dbf80,0xbf6dbec4,0xbf353f35,0x3ec43f6d,0xbf353f35,0x3e483f7b,0x3f6d3ec4,0x3f55bf0e
.long 0x3f80a50d,0x3f35bf35,0xa48dbf80,0xbf35bf35,0xbf35bf35,0xbf7bbe48,0xbf6d3ec4,0xbf0e3f55
.long 0x25543f80,0x3ec43f6d,0x3f353f35,0x3f6d3ec4,0x3f35bf35,0x3f0ebf55,0x3ec4bf6d,0x3e48bf7b
.long 0xbf808000,0xbf808000,0xbf808000,0xbf808000,0x25543f80,0xbe483f7b,0xbec43f6d,0xbf0e3f55
.long 0x3f80a50d,0x3f6d3ec4,0x3f353f35,0x3ec43f6d,0xa48dbf80,0x3f0ebf55,0x3f6dbec4,0x3f7b3e48
.long 0xbf808000,0xbf35bf35,0xa48dbf80,0x3f35bf35,0x25543f80,0xbf553f0e,0xbf6dbec4,0xbe48bf7b
.long 0x3f80a50d,0x3ec43f6d,0xbf353f35,0xbf6dbec4,0xa48dbf80,0x3f7bbe48,0x3ec43f6d,0xbf553f0e
.long 0xbf808000,0xa48dbf80,0x3f80a50d,0x25543f80,0x25543f80,0xbf7bbe48,0x3ec4bf6d,0x3f553f0e
.long 0x3f80a50d,0xbec43f6d,0xbf35bf35,0x3f6dbec4,0xa48dbf80,0x3f553f0e,0xbf6d3ec4,0x3e48bf7b
.long 0xbf808000,0x3f35bf35,0x25543f80,0xbf35bf35,0x25543f80,0xbf0ebf55,0x3f6d3ec4,0xbf7b3e48
.long 0x3f80a50d,0xbf6d3ec4,0x3f35bf35,0xbec43f6d,0xa48dbf80,0x3e483f7b,0xbec4bf6d,0x3f0e3f55
.long 0xbf808000,0x3f80a50d,0xbf808000,0x3f80a50d,0x25543f80,0x3e48bf7b,0xbec43f6d,0x3f0ebf55
.long 0x3f80a50d,0xbf6dbec4,0x3f353f35,0xbec4bf6d,0xa48dbf80,0xbf0e3f55,0x3f6dbec4,0xbf7bbe48
.long 0xbf808000,0x3f353f35,0xa48dbf80,0xbf353f35,0x25543f80,0x3f55bf0e,0xbf6dbec4,0x3e483f7b
.long 0x3f80a50d,0xbec4bf6d,0xbf353f35,0x3f6d3ec4,0xa48dbf80,0xbf7b3e48,0x3ec43f6d,0x3f55bf0e
.long 0xbf808000,0x25543f80,0x3f80a50d,0xa48dbf80,0x25543f80,0x3f7b3e48,0x3ec4bf6d,0xbf55bf0e
.long 0x3f80a50d,0x3ec4bf6d,0xbf35bf35,0xbf6d3ec4,0xa48dbf80,0xbf55bf0e,0xbf6d3ec4,0xbe483f7b
.long 0xbf808000,0xbf353f35,0x25543f80,0x3f353f35,0x25543f80,0x3f0e3f55,0x3f6d3ec4,0x3f7bbe48
.long 0x3f80a50d,0x3f6dbec4,0x3f35bf35,0x3ec4bf6d,0xa48dbf80,0xbe48bf7b,0xbec4bf6d,0xbf0ebf55
.long 0xbf808000,0xbf808000,0xbf808000,0xbf808000,0xbf353f35,0xbf553f0e,0xbf6d3ec4,0xbf7b3e48
.long 0x25543f80,0xbec43f6d,0xbf353f35,0xbf6d3ec4,0x3f353f35,0x3e483f7b,0xbec43f6d,0xbf553f0e
.long 0x3f80a50d,0x3f353f35,0x25543f80,0xbf353f35,0x3f35bf35,0x3f7b3e48,0x3ec43f6d,0xbf0e3f55
.long 0xa48dbf80,0x3f6dbec4,0x3f353f35,0xbec43f6d,0xbf35bf35,0x3f0ebf55,0x3f6d3ec4,0xbe483f7b
.long 0xbf808000,0xa48dbf80,0x3f80a50d,0x25543f80,0xbf353f35,0xbf0ebf55,0x3f6dbec4,0x3e483f7b
.long 0x25543f80,0xbf6dbec4,0x3f35bf35,0x3ec43f6d,0x3f353f35,0xbf7b3e48,0x3ec4bf6d,0x3f0e3f55
.long 0x3f80a50d,0xbf353f35,0xa48dbf80,0x3f353f35,0x3f35bf35,0xbe483f7b,0xbec4bf6d,0x3f553f0e
.long 0xa48dbf80,0x3ec43f6d,0xbf35bf35,0x3f6d3ec4,0xbf35bf35,0x3f553f0e,0xbf6dbec4,0x3f7b3e48
.long 0xbf808000,0x3f80a50d,0xbf808000,0x3f80a50d,0xbf353f35,0x3f55bf0e,0xbf6d3ec4,0x3f7bbe48
.long 0x25543f80,0x3ec4bf6d,0xbf353f35,0x3f6dbec4,0x3f353f35,0xbe48bf7b,0xbec43f6d,0x3f55bf0e
.long 0x3f80a50d,0xbf35bf35,0x25543f80,0x3f35bf35,0x3f35bf35,0xbf7bbe48,0x3ec43f6d,0x3f0ebf55
.long 0xa48dbf80,0xbf6d3ec4,0x3f353f35,0x3ec4bf6d,0xbf35bf35,0xbf0e3f55,0x3f6d3ec4,0x3e48bf7b
.long 0xbf808000,0x25543f80,0x3f80a50d,0xa48dbf80,0xbf353f35,0x3f0e3f55,0x3f6dbec4,0xbe48bf7b
.long 0x25543f80,0x3f6d3ec4,0x3f35bf35,0xbec4bf6d,0x3f353f35,0x3f7bbe48,0x3ec4bf6d,0xbf0ebf55
.long 0x3f80a50d,0x3f35bf35,0xa48dbf80,0xbf35bf35,0x3f35bf35,0x3e48bf7b,0xbec4bf6d,0xbf55bf0e
.long 0xa48dbf80,0xbec4bf6d,0xbf35bf35,0xbf6dbec4,0xbf35bf35,0xbf55bf0e,0xbf6dbec4,0xbf7bbe48
.long 0x35cd,0x35cd,0x35cd,0x35cd,0x35cd,0x34fd35c3,0x357135a6,0x35a63571
.long 0x35cd,0x357135a6,0x35c334fd,0x35c3b4fd,0x35cd,0x35a63571,0x35c3b4fd,0x34fdb5c3
.long 0x35cd,0x35c334fd,0x3571b5a6,0xb571b5a6,0x35cd,0x35cd1ae2,0x1b62b5cd,0xb5cd9ba9
.long 0x35cd,0x35c3b4fd,0xb571b5a6,0xb57135a6,0x35cd,0x35a6b571,0xb5c3b4fd,0x34fd35c3
.long 0x35cd,0x3571b5a6,0xb5c334fd,0x35c334fd,0x35cd,0x34fdb5c3,0xb57135a6,0x35a6b571
.long 0x35cd,0x1b62b5cd,0x35cd,0x1b62b5cd,0x35cd,0xb4fdb5c3,0x357135a6,0xb5a6b571
.long 0x35cd,0xb571b5a6,0x35c334fd,0xb5c334fd,0x35cd,0xb5a6b571,0x35c3b4fd,0xb4fd35c3
.long 0x35cd,0xb5c3b4fd,0x3571b5a6,0x357135a6,0x35cd,0xb5cd9ba9,0x1b62b5cd,0x35cd1ae2
.long 0x35cd,0xb5c334fd,0xb571b5a6,0x3571b5a6,0x35cd,0xb5a63571,0xb5c3b4fd,0xb4fdb5c3
.long 0x35cd,0xb57135a6,0xb5c334fd,0xb5c3b4fd,0x35cd,0xb4fd35c3,0xb57135a6,0xb5a63571
.long 0x0,0x0,0x0,0x0,0x0,0x0,0x0,0x0
.long 0x0,0x0,0x0,0x0,0x0,0x0,0x0,0x0
.long 0x0,0x0,0x0,0x0,0x0,0x0,0x0,0x0
.long 0x0,0x0,0x0,0x0,0x0,0x0,0x0,0x0
.long 0x0,0x0,0x0,0x0,0x0,0x0,0x0,0x0
.long 0x0,0x0,0x0,0x0,0x0,0x0,0x0,0x0
.long 0x35cd,0x35cd,0x35cd,0x35cd,0x35c334fd,0x35cd1ae2,0x35c3b4fd,0x35a6b571
.long 0x3571b5a6,0x1b62b5cd,0xb571b5a6,0xb5c3b4fd,0xb571b5a6,0xb5cd9ba9,0xb57135a6,0x34fd35c3
.long 0xb5c334fd,0x35cd,0x35c334fd,0x3571b5a6,0x35cd,0x35cd1ae2,0x1b62b5cd,0xb5cd9ba9
.long 0x35c334fd,0x1b62b5cd,0xb5c334fd,0x357135a6,0x3571b5a6,0xb5cd9ba9,0x357135a6,0x34fdb5c3
.long 0xb571b5a6,0x35cd,0x3571b5a6,0xb5c334fd,0xb5c334fd,0x35cd1ae2,0xb5c3b4fd,0x35a63571
.long 0x35cd,0x1b62b5cd,0x35cd,0x1b62b5cd,0x35c334fd,0xb5cd9ba9,0x35c3b4fd,0xb5a63571
.long 0x3571b5a6,0x35cd,0xb571b5a6,0x35c334fd,0xb571b5a6,0x35cd1ae2,0xb57135a6,0xb4fdb5c3
.long 0xb5c334fd,0x1b62b5cd,0x35c334fd,0xb57135a6,0x35cd,0xb5cd9ba9,0x1b62b5cd,0x35cd1ae2
.long 0x35c334fd,0x35cd,0xb5c334fd,0xb571b5a6,0x3571b5a6,0x35cd1ae2,0x357135a6,0xb4fd35c3
.long 0xb571b5a6,0x1b62b5cd,0x3571b5a6,0x35c3b4fd,0xb5c334fd,0xb5cd9ba9,0xb5c3b4fd,0xb5a6b571
.long 0x0,0x0,0x0,0x0,0x0,0x0,0x0,0x0
.long 0x0,0x0,0x0,0x0,0x0,0x0,0x0,0x0
.long 0x0,0x0,0x0,0x0,0x0,0x0,0x0,0x0
.long 0x0,0x0,0x0,0x0,0x0,0x0,0x0,0x0
.long 0x0,0x0,0x0,0x0,0x0,0x0,0x0,0x0
.long 0x0,0x0,0x0,0x0,0x0,0x0,0x0,0x0
.long 0x35cd,0x35cd,0x35cd,0x0,0x3571b5a6,0x34fdb5c3,0x1b62b5cd,0x0
.long 0xb5c334fd,0xb57135a6,0x35cd,0x0,0x35c334fd,0x35a6b571,0x1b62b5cd,0x0
.long 0xb571b5a6,0xb5c334fd,0x35cd,0x0,0x35cd,0x35cd1ae2,0x1b62b5cd,0x0
.long 0x3571b5a6,0xb5c3b4fd,0x35cd,0x0,0xb5c334fd,0x35a63571,0x1b62b5cd,0x0
.long 0x35c334fd,0xb571b5a6,0x35cd,0x0,0xb571b5a6,0x34fd35c3,0x1b62b5cd,0x0
.long 0x35cd,0x1b62b5cd,0x35cd,0x0,0x3571b5a6,0xb4fd35c3,0x1b62b5cd,0x0
.long 0xb5c334fd,0x3571b5a6,0x35cd,0x0,0x35c334fd,0xb5a63571,0x1b62b5cd,0x0
.long 0xb571b5a6,0x35c3b4fd,0x35cd,0x0,0x35cd,0xb5cd9ba9,0x1b62b5cd,0x0
.long 0x3571b5a6,0x35c334fd,0x35cd,0x0,0xb5c334fd,0xb5a6b571,0x1b62b5cd,0x0
.long 0x35c334fd,0x357135a6,0x35cd,0x0,0xb571b5a6,0xb4fdb5c3,0x1b62b5cd,0x0
.long 0x0,0x0,0x0,0x0,0x0,0x0,0x0,0x0
.long 0x0,0x0,0x0,0x0,0x0,0x0,0x0,0x0
.long 0x0,0x0,0x0,0x0,0x0,0x0,0x0,0x0
.long 0x0,0x0,0x0,0x0,0x0,0x0,0x0,0x0
.long 0x0,0x0,0x0,0x0,0x0,0x0,0x0,0x0
.long 0x0,0x0,0x0,0x0,0x0,0x0,0x0,0x0
.long 0x0,0x0,0x0,0x0,0x0,0x0,0x0,0x0
.long 0x0,0x0,0x0,0x0,0x0,0x0,0x0,0x0
.long 0x0,0x0,0x0,0x0,0x0,0x0,0x0,0x0
.long 0x0,0x0,0x0,0x0,0x0,0x0,0x0,0x0
.long 0x0,0x0,0x0,0x0,0x0,0x0,0x0,0x0
.long 0x0,0x0,0x0,0x0,0x0,0x0,0x0,0x0
.long 0x0,0x0,0x0,0x0,0x0,0x0,0x0,0x0
.long 0x0,0x0,0x0,0x0,0x0,0x0,0x0,0x0
.long 0x0,0x0,0x0,0x0,0x0,0x0,0x0,0x0
.long 0x0,0x0,0x0,0x0,0x0,0x0,0x0,0x0
.long 0x0,0x0,0x0,0x0,0x0,0x0,0x0,0x0
.long 0x0,0x0,0x0,0x0,0x0,0x0,0x0,0x0
.long 0x0,0x0,0x0,0x0,0x0,0x0,0x0,0x0
.long 0x0,0x0,0x0,0x0,0x0,0x0,0x0,0x0
.long 0x0,0x0,0x0,0x0,0x0,0x0,0x0,0x0
.long 0x0,0x0,0x0,0x0,0x0,0x0,0x0,0x0
.long 0x8000b5cd,0x8000b5cd,0x8000b5cd,0x8000b5cd,0x8000b5cd,0xb4fdb5c3,0xb571b5a6,0xb5a6b571
.long 0x8000b5cd,0xb571b5a6,0xb5c3b4fd,0xb5c334fd,0x8000b5cd,0xb5a6b571,0xb5c334fd,0xb4fd35c3
.long 0x8000b5cd,0xb5c3b4fd,0xb57135a6,0x357135a6,0x8000b5cd,0xb5cd9ae2,0x9b6235cd,0x35cd1ba9
.long 0x8000b5cd,0xb5c334fd,0x357135a6,0x3571b5a6,0x8000b5cd,0xb5a63571,0x35c334fd,0xb4fdb5c3
.long 0x8000b5cd,0xb57135a6,0x35c3b4fd,0xb5c3b4fd,0x8000b5cd,0xb4fd35c3,0x3571b5a6,0xb5a63571
.long 0x8000b5cd,0x9b6235cd,0x8000b5cd,0x9b6235cd,0x8000b5cd,0x34fd35c3,0xb571b5a6,0x35a63571
.long 0x8000b5cd,0x357135a6,0xb5c3b4fd,0x35c3b4fd,0x8000b5cd,0x35a63571,0xb5c334fd,0x34fdb5c3
.long 0x8000b5cd,0x35c334fd,0xb57135a6,0xb571b5a6,0x8000b5cd,0x35cd1ba9,0x9b6235cd,0xb5cd9ae2
.long 0x8000b5cd,0x35c3b4fd,0x357135a6,0xb57135a6,0x8000b5cd,0x35a6b571,0x35c334fd,0x34fd35c3
.long 0x8000b5cd,0x3571b5a6,0x35c3b4fd,0x35c334fd,0x8000b5cd,0x34fdb5c3,0x3571b5a6,0x35a6b571
.long 0x80008000,0x80008000,0x80008000,0x80008000,0x80008000,0x80008000,0x80008000,0x80008000
.long 0x80008000,0x80008000,0x80008000,0x80008000,0x80008000,0x80008000,0x80008000,0x80008000
.long 0x80008000,0x80008000,0x80008000,0x80008000,0x80008000,0x80008000,0x80008000,0x80008000
.long 0x80008000,0x80008000,0x80008000,0x80008000,0x80008000,0x80008000,0x80008000,0x80008000
.long 0x80008000,0x80008000,0x80008000,0x80008000,0x80008000,0x80008000,0x80008000,0x80008000
.long 0x80008000,0x80008000,0x80008000,0x80008000,0x80008000,0x80008000,0x80008000,0x80008000
.long 0x8000b5cd,0x8000b5cd,0x8000b5cd,0x8000b5cd,0xb5c3b4fd,0xb5cd9ae2,0xb5c334fd,0xb5a63571
.long 0xb57135a6,0x9b6235cd,0x357135a6,0x35c334fd,0x357135a6,0x35cd1ba9,0x3571b5a6,0xb4fdb5c3
.long 0x35c3b4fd,0x8000b5cd,0xb5c3b4fd,0xb57135a6,0x8000b5cd,0xb5cd9ae2,0x9b6235cd,0x35cd1ba9
.long 0xb5c3b4fd,0x9b6235cd,0x35c3b4fd,0xb571b5a6,0xb57135a6,0x35cd1ba9,0xb571b5a6,0xb4fd35c3
.long 0x357135a6,0x8000b5cd,0xb57135a6,0x35c3b4fd,0x35c3b4fd,0xb5cd9ae2,0x35c334fd,0xb5a6b571
.long 0x8000b5cd,0x9b6235cd,0x8000b5cd,0x9b6235cd,0xb5c3b4fd,0x35cd1ba9,0xb5c334fd,0x35a6b571
.long 0xb57135a6,0x8000b5cd,0x357135a6,0xb5c3b4fd,0x357135a6,0xb5cd9ae2,0x3571b5a6,0x34fd35c3
.long 0x35c3b4fd,0x9b6235cd,0xb5c3b4fd,0x3571b5a6,0x8000b5cd,0x35cd1ba9,0x9b6235cd,0xb5cd9ae2
.long 0xb5c3b4fd,0x8000b5cd,0x35c3b4fd,0x357135a6,0xb57135a6,0xb5cd9ae2,0xb571b5a6,0x34fdb5c3
.long 0x357135a6,0x9b6235cd,0xb57135a6,0xb5c334fd,0x35c3b4fd,0x35cd1ba9,0x35c334fd,0x35a63571
.long 0x80008000,0x80008000,0x80008000,0x80008000,0x80008000,0x80008000,0x80008000,0x80008000
.long 0x80008000,0x80008000,0x80008000,0x80008000,0x80008000,0x80008000,0x80008000,0x80008000
.long 0x80008000,0x80008000,0x80008000,0x80008000,0x80008000,0x80008000,0x80008000,0x80008000
.long 0x80008000,0x80008000,0x80008000,0x80008000,0x80008000,0x80008000,0x80008000,0x80008000
.long 0x80008000,0x80008000,0x80008000,0x80008000,0x80008000,0x80008000,0x80008000,0x80008000
.long 0x80008000,0x80008000,0x80008000,0x80008000,0x80008000,0x80008000,0x80008000,0x80008000
.long 0x8000b5cd,0x8000b5cd,0x8000b5cd,0x80008000,0xb57135a6,0xb4fd35c3,0x9b6235cd,0x80008000
.long 0x35c3b4fd,0x3571b5a6,0x8000b5cd,0x80008000,0xb5c3b4fd,0xb5a63571,0x9b6235cd,0x80008000
.long 0x357135a6,0x35c3b4fd,0x8000b5cd,0x80008000,0x8000b5cd,0xb5cd9ae2,0x9b6235cd,0x80008000
.long 0xb57135a6,0x35c334fd,0x8000b5cd,0x80008000,0x35c3b4fd,0xb5a6b571,0x9b6235cd,0x80008000
.long 0xb5c3b4fd,0x357135a6,0x8000b5cd,0x80008000,0x357135a6,0xb4fdb5c3,0x9b6235cd,0x80008000
.long 0x8000b5cd,0x9b6235cd,0x8000b5cd,0x80008000,0xb57135a6,0x34fdb5c3,0x9b6235cd,0x80008000
.long 0x35c3b4fd,0xb57135a6,0x8000b5cd,0x80008000,0xb5c3b4fd,0x35a6b571,0x9b6235cd,0x80008000
.long 0x357135a6,0xb5c334fd,0x8000b5cd,0x80008000,0x8000b5cd,0x35cd1ba9,0x9b6235cd,0x80008000
.long 0xb57135a6,0xb5c3b4fd,0x8000b5cd,0x80008000,0x35c3b4fd,0x35a63571,0x9b6235cd,0x80008000
.long 0xb5c3b4fd,0xb571b5a6,0x8000b5cd,0x80008000,0x357135a6,0x34fd35c3,0x9b6235cd,0x80008000
.long 0x80008000,0x80008000,0x80008000,0x80008000,0x80008000,0x80008000,0x80008000,0x80008000
.long 0x80008000,0x80008000,0x80008000,0x80008000,0x80008000,0x80008000,0x80008000,0x80008000
.long 0x80008000,0x80008000,0x80008000,0x80008000,0x80008000,0x80008000,0x80008000,0x80008000
.long 0x80008000,0x80008000,0x80008000,0x80008000,0x80008000,0x80008000,0x80008000,0x80008000
.long 0x80008000,0x80008000,0x80008000,0x80008000,0x80008000,0x80008000,0x80008000,0x80008000
.long 0x80008000,0x80008000,0x80008000,0x80008000,0x80008000,0x80008000,0x80008000,0x80008000
.long 0x80008000,0x80008000,0x80008000,0x80008000,0x80008000,0x80008000,0x80008000,0x80008000
.long 0x80008000,0x80008000,0x80008000,0x80008000,0x80008000,0x80008000,0x80008000,0x80008000
.long 0x80008000,0x80008000,0x80008000,0x80008000,0x80008000,0x80008000,0x80008000,0x80008000
.long 0x80008000,0x80008000,0x80008000,0x80008000,0x80008000,0x80008000,0x80008000,0x80008000
.long 0x80008000,0x80008000,0x80008000,0x80008000,0x80008000,0x80008000,0x80008000,0x80008000
.long 0x80008000,0x80008000,0x80008000,0x80008000,0x80008000,0x80008000,0x80008000,0x80008000
.long 0x80008000,0x80008000,0x80008000,0x80008000,0x80008000,0x80008000,0x80008000,0x80008000
.long 0x80008000,0x80008000,0x80008000,0x80008000,0x80008000,0x80008000,0x80008000,0x80008000
.long 0x80008000,0x80008000,0x80008000,0x80008000,0x80008000,0x80008000,0x80008000,0x80008000
.long 0x80008000,0x80008000,0x80008000,0x80008000,0x80008000,0x80008000,0x80008000,0x80008000
.long 0x80008000,0x80008000,0x80008000,0x80008000,0x80008000,0x80008000,0x80008000,0x80008000
.long 0x80008000,0x80008000,0x80008000,0x80008000,0x80008000,0x80008000,0x80008000,0x80008000
.long 0x80008000,0x80008000,0x80008000,0x80008000,0x80008000,0x80008000,0x80008000,0x80008000
.long 0x80008000,0x80008000,0x80008000,0x80008000,0x80008000,0x80008000,0x80008000,0x80008000
.long 0x80008000,0x80008000,0x80008000,0x80008000,0x80008000,0x80008000,0x80008000,0x80008000
.long 0x80008000,0x80008000,0x80008000,0x80008000,0x80008000,0x80008000,0x80008000,0x80008000
.size ctab, 12288
.section .rodata,"a"
.p2align 6
.amdhsa_kernel recurrent_scan__spectral_gfnet__mixer_channel_mlp__prompt_kernel
  .amdhsa_next_free_vgpr 168
  .amdhsa_next_free_sgpr 102
  .amdhsa_accum_offset 168
  .amdhsa_group_segment_fixed_size 0
  .amdhsa_kernarg_size 88
  .amdhsa_user_sgpr_count 2
  .amdhsa_user_sgpr_kernarg_segment_ptr 1
  .amdhsa_system_sgpr_workgroup_id_x 1
  .amdhsa_float_denorm_mode_32 3
.end_amdhsa_kernel
```
